```python
import torch

def _softmax(x, axis=-1):
    return torch.softmax(x, dim=axis)
def _gelu(x):
    return torch.nn.functional.gelu(x, approximate="tanh")
def _silu(x):
    return torch.nn.functional.silu(x)
def _sigmoid(x):
    return torch.sigmoid(x)
def _layernorm(x, axis=-1, eps=1e-5):
    m = x.mean(dim=axis, keepdim=True)
    v = x.var(dim=axis, keepdim=True, unbiased=False)
    return (x - m) / torch.sqrt(v + eps)
def _scatter_add(tgt, idx, src, axis=0):
    return tgt.clone().index_add_(axis, idx, src)
def _segment_sum(src, seg, n):
    out = torch.zeros((n,) + src.shape[1:], dtype=src.dtype)
    return out.index_add_(0, seg, src)
def _pad(x, pw):
    flat = tuple(v for pair in reversed(pw) for v in pair)
    return torch.nn.functional.pad(x, flat)

kernel_name = 'interleave_layers__sliding_block_cached__sliding_block_cached__decode'

def setup_inputs():

    _w = (lambda a: (lambda t: t.to(torch.bfloat16) if t.is_floating_point() else t)(torch.as_tensor(a)))
    def _A_setup():
        B, Sq, D = 1, 1, 1024
        Hq, Hkv, Sk, Dh = 32, 4, 65536, 128
        assert Hq % Hkv == 0, (Hq, Hkv)
        return {
            "x": _w((lambda *s: torch.randn(*s, dtype=torch.bfloat16) * 0.05)(B, Sq, D)),
            "k_cache": _w((lambda *s: torch.randn(*s, dtype=torch.bfloat16) * 0.8)(B, Hkv, Sk, Dh)),
            "v_cache": _w((lambda *s: torch.randn(*s, dtype=torch.bfloat16) * 3.2)(B, Hkv, Sk, Dh)),
            "wq": _w((lambda *s: torch.randn(*s, dtype=torch.bfloat16) * 0.8)(D, Hq * Dh) * (D ** -0.5)),
            "wo": _w((lambda *s: torch.randn(*s, dtype=torch.bfloat16) * 3.2)(Hq * Dh, D) * ((Hq * Dh) ** -0.5)),
        }
    _A_in = _A_setup()

    def _B_setup():
        B, Sq, D = 1, 1, 1024
        Hq, Hkv, Sk, Dh = 32, 4, 65536, 128
        assert Hq % Hkv == 0, (Hq, Hkv)
        return {
            "x": _w((lambda *s: torch.randn(*s, dtype=torch.bfloat16) * 0.05)(B, Sq, D)),
            "k_cache": _w((lambda *s: torch.randn(*s, dtype=torch.bfloat16) * 1.6)(B, Hkv, Sk, Dh)),
            "v_cache": _w((lambda *s: torch.randn(*s, dtype=torch.bfloat16) * 1.6)(B, Hkv, Sk, Dh)),
            "wq": _w((lambda *s: torch.randn(*s, dtype=torch.bfloat16) * 1.6)(D, Hq * Dh) * (D ** -0.5)),
            "wo": _w((lambda *s: torch.randn(*s, dtype=torch.bfloat16) * 1.6)(Hq * Dh, D) * ((Hq * Dh) ** -0.5)),
        }
    _B_in = _B_setup()

    return {
        "A_x": _A_in["x"],
        "A_k_cache": _A_in["k_cache"],
        "A_v_cache": _A_in["v_cache"],
        "A_wq": _A_in["wq"],
        "A_wo": _A_in["wo"],
        "B_x": _B_in["x"],
        "B_k_cache": _B_in["k_cache"],
        "B_v_cache": _B_in["v_cache"],
        "B_wq": _B_in["wq"],
        "B_wo": _B_in["wo"],
    }

def reference(A_x, A_k_cache, A_v_cache, A_wq, A_wo, B_x, B_k_cache, B_v_cache, B_wq, B_wo):
    def _A_ref(x, k_cache, v_cache, wq, wo):
        B, Sq, D = x.shape
        Hq, Dh = 32, 128
        Hkv, Sk = k_cache.shape[1], k_cache.shape[2]
        W = min(4096, max(256, Sk // 4))
        rep = Hq // Hkv
        q = (lambda x, *d: x.permute(*d))((x @ wq).reshape(B, Sq, Hq, Dh), 0, 2, 1, 3)
        k = (lambda x, n, axis: torch.repeat_interleave(x, n, dim=axis))(k_cache[:, :, Sk - W:, :], rep, axis=1)
        v = (lambda x, n, axis: torch.repeat_interleave(x, n, dim=axis))(v_cache[:, :, Sk - W:, :], rep, axis=1)
        scores = torch.einsum("bhqd,bhkd->bhqk", q, k) * (Dh ** -0.5)
        p = _softmax(scores, axis=-1)
        o = torch.einsum("bhqk,bhkd->bhqd", p, v)
        return (lambda x, *d: x.permute(*d))(o, 0, 2, 1, 3).reshape(B, Sq, Hq * Dh) @ wo

    def _B_ref(x, k_cache, v_cache, wq, wo):
        B, Sq, D = x.shape
        Hq, Dh = 32, 128
        Hkv, Sk = k_cache.shape[1], k_cache.shape[2]
        W = min(4096, max(256, Sk // 4))
        rep = Hq // Hkv
        q = (lambda x, *d: x.permute(*d))((x @ wq).reshape(B, Sq, Hq, Dh), 0, 2, 1, 3)
        k = (lambda x, n, axis: torch.repeat_interleave(x, n, dim=axis))(k_cache[:, :, Sk - W:, :], rep, axis=1)
        v = (lambda x, n, axis: torch.repeat_interleave(x, n, dim=axis))(v_cache[:, :, Sk - W:, :], rep, axis=1)
        scores = torch.einsum("bhqd,bhkd->bhqk", q, k) * (Dh ** -0.5)
        p = _softmax(scores, axis=-1)
        o = torch.einsum("bhqk,bhkd->bhqd", p, v)
        return (lambda x, *d: x.permute(*d))(o, 0, 2, 1, 3).reshape(B, Sq, Hq * Dh) @ wo

    x = A_x
    x = x + _A_ref(_layernorm(x, axis=-1), A_k_cache, A_v_cache, A_wq, A_wo)
    x = x + _B_ref(_layernorm(x, axis=-1), B_k_cache, B_v_cache, B_wq, B_wo)
    x = x + _A_ref(_layernorm(x, axis=-1), A_k_cache, A_v_cache, A_wq, A_wo)
    x = x + _B_ref(_layernorm(x, axis=-1), B_k_cache, B_v_cache, B_wq, B_wo)
    return x
```

```asm
; @launch grid=(256,1,1) block=(256,1,1) lds=142976
.amdgcn_target "amdgcn-amd-amdhsa--gfx950"
.text
.globl interleave_layers__sliding_block_cached__sliding_block_cached__decode_kernel
.p2align 8
.type interleave_layers__sliding_block_cached__sliding_block_cached__decode_kernel,@function
interleave_layers__sliding_block_cached__sliding_block_cached__decode_kernel:
s_cmp_ge_u32 s2, 256
s_cbranch_scc1 L_end
s_load_dwordx16 s[4:19], s[0:1], 0
s_load_dwordx8 s[20:27], s[0:1], 64
s_load_dwordx2 s[28:29], s[0:1], 96
s_bitcmp1_b32 s2, 0
s_cbranch_scc1 L_B
s_getpc_b64 s[58:59]
L_pcA:
v_lshlrev_b32 v212, 6, v0
v_min_u32 v212, L_endA-L_pcA, v212
v_add_co_u32 v160, vcc, s58, v212
v_mov_b32 v212, s59
s_nop 0
v_addc_co_u32 v161, vcc, 0, v212, vcc
global_load_dword v218, v[160:161], off
v_lshrrev_b32 v212, 6, v0
v_mov_b32 v209, v0
v_and_b32 v0, 63, v0
v_and_b32 v210, 15, v0
v_readfirstlane_b32 s30, v212
s_bfe_u32 s31, s2, 0x20001
s_lshr_b32 s32, s2, 3
s_lshr_b32 s33, s2, 5
s_and_b32 s34, s32, 3
s_and_b32 s35, s32, 7
s_lshr_b32 s36, s2, 6
v_lshrrev_b32 v211, 4, v0
v_lshrrev_b32 v217, 5, v0
v_and_b32 v212, 31, v0
v_lshlrev_b32 v216, 4, v212
v_lshlrev_b32 v212, 6, v217
v_xor_b32 v213, v216, v212
s_and_b32 s60, s30, 1
s_lshl_b32 s57, s60, 7
v_xor_b32 v213, s57, v213
s_lshl_b32 s57, s33, 20
s_lshl_b32 s58, s30, 14
s_add_u32 s57, s57, s58
s_lshl_b32 s58, s31, 11
s_add_u32 s57, s57, s58
s_lshl_b32 s58, s34, 9
s_add_u32 s57, s57, s58
v_lshl_add_u32 v183, v217, 13, v213
v_add_u32 v183, s57, v183
s_lshl_b32 s44, s30, 10
s_mul_i32 s45, s30, 8320
s_lshl_b32 s3, s30, 13
s_lshr_b32 s57, s31, 1
s_lshl_b32 s57, s57, 19
s_and_b32 s58, s31, 1
s_lshl_b32 s58, s58, 16
s_add_u32 s57, s57, s58
s_add_u32 s62, s57, 2097152
s_lshl_b32 s57, s31, 3
s_add_u32 s57, s57, s35
s_lshl_b32 s57, s57, 8
s_lshl_b32 s58, s36, 15
s_add_u32 s63, s57, s58
s_lshl_b32 s57, s31, 14
s_add_u32 s64, s57, 1048576
s_lshl_b32 s58, s33, 8
s_lshl_b32 s59, s34, 12
s_add_u32 s59, s59, s58
s_add_u32 s65, s64, s59
s_lshl_b32 s66, s31, 12
s_lshl_b32 s57, s31, 13
s_add_u32 s69, s57, 1146880
s_lshl_b32 s59, s34, 11
s_add_u32 s59, s59, s58
s_add_u32 s67, s69, s59
s_lshl_b32 s57, s32, 7
s_add_u32 s68, s66, s57
v_lshlrev_b32 v215, 4, v210
v_lshl_add_u32 v212, v211, 11, v215
v_add_u32 v178, s65, v212
v_bfe_u32 v212, v0, 3, 1
v_mul_u32_u24 v212, 16256, v212
s_add_u32 s57, s68, 1114112
v_add3_u32 v212, v212, s57, v215
v_cmp_le_u32 vcc, 32, v0
s_nop 1
v_cndmask_b32 v178, v178, v212, vcc
v_add_u32 v212, s67, v215
v_cmp_le_u32 vcc, 48, v0
s_nop 1
v_cndmask_b32 v178, v178, v212, vcc
s_lshl_b32 s57, s30, 15
s_lshl_b32 s58, s32, 9
s_add_u32 s57, s57, s58
s_add_u32 s57, s57, s62
v_lshl_add_u32 v212, v217, 14, v216
v_add_u32 v212, s57, v212
s_movk_i32 s57, 128
s_movk_i32 s58, 192
v_cmp_le_u32 vcc, s57, v209
s_nop 1
v_cndmask_b32 v178, v212, v178, vcc
v_lshl_add_u32 v212, v211, 13, v215
v_add_u32 v212, s63, v212
v_cmp_le_u32 vcc, s58, v209
s_nop 1
v_cndmask_b32 v177, v178, v212, vcc
v_mov_b64 v[116:117], -1
v_mov_b64 v[118:119], -1
v_and_b32 v214, 1, v211
v_lshl_add_u32 v214, v214, 3, v215
s_lshl_b32 s57, s33, 8
v_add_u32 v219, s57, v214
v_lshlrev_b32 v220, 5, v0
s_getreg_b32 s54, hwreg(HW_REG_XCC_ID, 0, 4)
s_bfe_u32 s55, s54, 0x10002
s_lshl_b32 s54, s54, 28
s_waitcnt lgkmcnt(0)
s_add_u32 s28, s28, 0x1fffff
s_addc_u32 s29, s29, 0
s_and_b32 s28, s28, 0xffe00000
global_load_dwordx2 v[140:141], v219, s[4:5]
global_load_dwordx4 v[20:23], v220, s[4:5]
global_load_dwordx4 v[24:27], v220, s[4:5] offset:16
s_add_u32 s38, s28, 0
s_addc_u32 s39, s29, 0
s_add_u32 s40, s28, 262144
s_addc_u32 s41, s29, 0
s_add_u32 s58, s28, 1736704
s_addc_u32 s59, s29, 0
s_load_dword s26, s[58:59], 0
global_store_dwordx4 v177, v[116:119], s[38:39] sc1
global_store_dwordx4 v177, v[116:119], s[40:41] sc1
s_add_u32 m0, s44, 77312
s_nop 0
global_load_lds_dwordx4 v183, s[10:11] nt
s_add_u32 m0, s44, 81416
v_add_u32 v187, 65536, v183
global_load_lds_dwordx4 v187, s[10:11] nt
s_add_u32 m0, s44, 85520
v_add_u32 v187, 131072, v183
global_load_lds_dwordx4 v187, s[10:11] nt
s_add_u32 m0, s44, 89624
v_add_u32 v187, 196608, v183
global_load_lds_dwordx4 v187, s[10:11] nt
s_add_u32 m0, s44, 93728
v_add_u32 v187, 262144, v183
global_load_lds_dwordx4 v187, s[10:11] nt
s_add_u32 m0, s44, 97832
v_add_u32 v187, 327680, v183
global_load_lds_dwordx4 v187, s[10:11] nt
s_add_u32 m0, s44, 101936
v_add_u32 v187, 393216, v183
global_load_lds_dwordx4 v187, s[10:11] nt
s_lshl_b32 s57, s31, 24
s_lshl_b32 s58, s32, 15
s_add_u32 s57, s57, s58
s_add_u32 s57, s57, s3
s_add_u32 s57, s57, 15728640
v_xor_b32 v212, v210, v217
v_lshlrev_b32 v212, 4, v212
v_lshl_add_u32 v184, v211, 8, v212
v_add_u32 v184, s57, v184
v_and_b32 v221, 1, v211
v_lshlrev_b32 v221, 6, v221
v_xor_b32 v212, v215, v221
v_lshl_add_u32 v185, v211, 8, v212
v_add_u32 v185, s57, v185
s_lshl_b32 s57, s31, 21
s_lshl_b32 s58, s35, 18
s_add_u32 s57, s57, s58
s_lshl_b32 s58, s30, 12
s_add_u32 s57, s57, s58
s_lshl_b32 s58, s36, 9
s_add_u32 s57, s57, s58
v_lshl_add_u32 v186, v217, 11, v213
v_add_u32 v186, s57, v186
s_lshl_b32 s57, s2, 7
s_lshl_b32 s58, s30, 4
s_add_u32 s57, s57, s58
s_add_u32 s57, s57, 1703936
v_mov_b32 v180, s57
v_lshlrev_b32 v212, 4, v0
s_lshl_b32 s61, s30, 11
s_lshl_b32 s57, s33, 14
s_add_u32 s57, s57, s61
s_add_u32 s57, s57, 131072
v_add_u32 v166, s57, v212
s_lshl_b32 s57, s30, 12
s_add_u32 s57, s57, s64
v_add_u32 v167, s57, v212
s_add_u32 s57, s61, s69
v_add_u32 v168, s57, v212
s_lshr_b32 s58, s35, 1
s_and_b32 s59, s35, 1
s_lshl_b32 s57, s58, 14
s_add_u32 s57, s57, s62
s_lshl_b32 s70, s59, 8
s_add_u32 s57, s57, s70
s_lshl_b32 s70, s30, 12
s_add_u32 s57, s57, s70
v_lshl_add_u32 v212, v211, 9, v215
v_add_u32 v170, s57, v212
s_lshl_b32 s58, s58, 4
s_lshl_b32 s59, s59, 2
s_add_u32 s57, s58, s59
s_add_u32 s57, s57, s66
s_add_u32 s57, s57, s44
s_add_u32 s57, s57, 1130496
v_and_b32 v216, 1, v0
v_lshl_add_u32 v222, v216, 2, v211
v_and_b32 v220, 7, v0
v_and_b32 v212, 8, v0
v_cmp_ne_u32 vcc, 0, v212
s_nop 1
v_cndmask_b32 v222, v220, v222, vcc
v_lshl_add_u32 v171, v222, 7, s57
s_lshl_b32 s57, s30, 7
s_add_u32 s57, s57, s66
s_add_u32 s57, s57, 1114112
v_bfe_u32 v212, v0, 1, 3
v_lshlrev_b32 v212, 9, v212
v_lshl_add_u32 v212, v216, 4, v212
v_add_u32 v169, s57, v212
s_and_b32 s57, s2, 7
s_lshl_b32 s58, s30, 3
s_add_u32 s57, s57, s58
v_lshl_add_u32 v212, v220, 5, s57
s_lshl_b32 s57, s36, 6
s_lshl_b32 s58, s30, 1
s_add_u32 s57, s57, s58
s_add_u32 s57, s57, 1
v_lshl_add_u32 v222, v220, 3, s57
v_cmp_le_u32 vcc, 32, v0
s_nop 1
v_cndmask_b32 v212, v212, v222, vcc
v_bfe_u32 v222, v0, 3, 2
v_lshlrev_b32 v222, 4, v222
v_lshl_add_u32 v212, v212, 7, v222
v_add_u32 v179, 1703936, v212
s_lshl_b32 s57, s33, 14
s_lshl_b32 s58, s34, 11
s_add_u32 s57, s57, s58
s_add_u32 s59, s57, 655360
v_and_b32 v212, 3, v0
v_lshl_add_u32 v182, v212, 9, s59
s_lshl_b32 s58, s31, 9
s_add_u32 s57, s57, s58
s_lshl_b32 s58, s30, 7
s_add_u32 s57, s57, s58
s_add_u32 s57, s57, 524288
v_lshl_add_u32 v181, v216, 13, s57
v_lshl_add_u32 v222, v210, 2, v221
s_lshl_b32 s70, s60, 7
s_lshr_b32 s71, s30, 1
s_lshl_b32 s57, s71, 11
s_add_u32 s57, s57, s65
s_add_u32 s57, s57, s70
v_add_u32 v172, s57, v222
s_lshl_b32 s57, s71, 18
s_add_u32 s57, s57, s67
s_add_u32 s57, s57, s70
v_add_u32 v212, s57, v222
v_cmp_le_u32 vcc, 32, v0
s_nop 1
v_cndmask_b32 v172, v172, v212, vcc
s_lshl_b32 s57, s71, 14
s_add_u32 s57, s57, s63
s_add_u32 s57, s57, s70
v_lshl_add_u32 v212, v217, 13, v222
v_add_u32 v176, s57, v212
s_lshl_b32 s57, s32, 9
s_lshl_b32 s58, s30, 6
s_add_u32 s57, s57, s58
s_add_u32 s57, s57, s62
v_lshlrev_b32 v212, 2, v210
v_lshl_add_u32 v212, v211, 14, v212
v_add_u32 v174, s57, v212
s_lshl_b32 s57, s30, 4
s_add_u32 s58, s57, s68
s_add_u32 s58, s58, 1114112
v_lshl_add_u32 v173, v211, 2, s58
s_add_u32 s58, s68, 1130496
v_lshl_add_u32 v175, v211, 4, s58
s_lshl_b64 s[48:49], 1, s57
s_mov_b32 s50, 0xcccccccc
s_mov_b32 s51, 0xcccccccc
s_mov_b32 s52, 0x10001
s_mov_b32 s53, 0x10001
s_and_b32 s57, s33, 1
s_cmp_eq_u32 s57, s71
s_cselect_b32 s46, 0x3d800000, 0
s_mov_b32 s56, 0x03020302
s_mov_b32 s15, 0
s_mov_b32 s14, 0
v_lshrrev_b32 v212, 1, v211
v_mul_u32_u24 v212, 12, v212
v_and_b32 v188, 1, v211
v_lshl_add_u32 v212, v188, 0, v212
v_xor_b32 v212, v212, v210
v_lshlrev_b32 v212, 4, v212
v_lshl_add_u32 v194, v211, 8, v212
v_lshrrev_b32 v212, 1, v211
v_mul_u32_u24 v212, 12, v212
v_and_b32 v188, 1, v211
v_lshl_add_u32 v212, v188, 1, v212
v_xor_b32 v212, v212, v210
v_lshlrev_b32 v212, 4, v212
v_lshl_add_u32 v196, v211, 8, v212
s_mul_i32 s57, s60, 1056
v_add_u32 v195, s57, v194
v_bfe_u32 v222, v0, 1, 2
v_bfe_u32 v219, v0, 3, 1
v_mul_u32_u24 v219, 1056, v219
v_lshl_add_u32 v219, v222, 8, v219
v_lshl_add_u32 v219, v216, 3, v219
v_lshrrev_b32 v212, 4, v221
v_add_u32 v219, v219, v212
v_lshrrev_b32 v212, 1, v222
v_mul_u32_u24 v212, 12, v212
v_and_b32 v188, 1, v222
v_lshl_add_u32 v212, v188, 0, v212
s_lshl_b32 s57, s71, 2
s_add_u32 s57, s57, s60
v_xor_b32 v222, s57, v212
v_lshl_add_u32 v189, v222, 4, v219
v_lshlrev_b32 v188, 3, v217
v_xor_b32 v222, v222, v188
v_lshl_add_u32 v191, v222, 4, v219
v_add_u32 v191, 4224, v191
s_lshl_b32 s57, s30, 2
v_add_u32 v222, s57, v217
v_xor_b32 v222, v222, v212
v_lshl_add_u32 v190, v222, 4, v219
v_add_u32 v190, 2112, v190
v_and_b32 v216, 3, v210
v_lshrrev_b32 v219, 2, v210
v_lshrrev_b32 v212, 1, v219
v_mul_u32_u24 v212, 12, v212
v_and_b32 v188, 1, v219
v_lshl_add_u32 v212, v188, 1, v212
s_lshl_b32 s57, s60, 1
v_lshl_add_u32 v222, v211, 2, s57
v_xor_b32 v222, v222, v212
v_lshlrev_b32 v222, 4, v222
v_lshl_add_u32 v222, v219, 8, v222
s_mul_i32 s57, s71, 1056
s_add_u32 s57, s57, 6336
v_lshl_add_u32 v222, v216, 2, v222
v_add_u32 v197, s57, v222
v_lshlrev_b32 v199, 5, v211
v_add_u32 v199, 8448, v199
s_lshl_b32 s57, s30, 3
v_add_u32 v198, s57, v199
s_add_u32 s58, s57, 8576
v_mov_b32 v200, s58
s_add_u32 s58, s57, 8608
v_mov_b32 v203, s58
v_lshrrev_b32 v212, 2, v221
v_add_u32 v201, 8576, v212
v_sub_u32 v202, 8592, v212
s_mul_i32 s57, s30, 528
s_add_u32 s57, s57, 8640
v_lshl_add_u32 v192, v214, 1, s57
s_lshl_b32 s57, s60, 8
s_add_u32 s57, s57, 8640
v_lshl_add_u32 v212, v221, 1, s57
v_lshl_add_u32 v212, v219, 5, v212
v_lshl_add_u32 v193, v216, 2, v212
v_mul_u32_u24 v212, 4104, v211
v_lshl_add_u32 v212, v219, 9, v212
v_add_u32 v212, 77312, v212
s_lshl_b32 s57, s30, 3
v_add_u32 v222, s57, v216
v_lshlrev_b32 v188, 2, v219
v_xor_b32 v222, v222, v188
v_lshl_add_u32 v204, v222, 4, v212
v_xor_b32 v222, 4, v222
v_lshl_add_u32 v205, v222, 4, v212
v_mul_u32_u24 v212, 1032, v211
v_lshrrev_b32 v188, 1, v219
v_mul_u32_u24 v188, 8320, v188
v_add_u32 v212, v212, v188
v_and_b32 v215, 1, v219
v_lshl_add_u32 v212, v215, 8, v212
s_lshl_b32 s57, s30, 2
v_add_u32 v222, s57, v216
v_lshlrev_b32 v188, 2, v215
v_xor_b32 v222, v222, v188
v_lshl_add_u32 v212, v222, 4, v212
v_add_u32 v206, 44032, v212
v_xor_b32 v212, v211, v210
v_lshlrev_b32 v212, 4, v212
v_lshl_add_u32 v212, v210, 9, v212
s_add_u32 s57, s3, 11264
v_add_u32 v207, s57, v212
v_lshlrev_b32 v215, 4, v215
v_mov_b32 v213, 0xffff
v_lshlrev_b32 v213, v215, v213
v_cmp_eq_u32 vcc, 0, v216
s_nop 1
v_cndmask_b32 v16, 0, v213, vcc
v_and_b32 v4, 0x3f803f80, v16
v_cmp_eq_u32 vcc, 1, v216
s_nop 1
v_cndmask_b32 v17, 0, v213, vcc
v_and_b32 v5, 0x3f803f80, v17
v_cmp_eq_u32 vcc, 2, v216
s_nop 1
v_cndmask_b32 v18, 0, v213, vcc
v_and_b32 v6, 0x3f803f80, v18
v_cmp_eq_u32 vcc, 3, v216
s_nop 1
v_cndmask_b32 v19, 0, v213, vcc
v_and_b32 v7, 0x3f803f80, v19
v_cmp_gt_u32 vcc, 8, v210
s_nop 1
v_cndmask_b32 v8, 0, v4, vcc
v_sub_u32 v12, v4, v8
v_cndmask_b32 v9, 0, v5, vcc
v_sub_u32 v13, v5, v9
v_cndmask_b32 v10, 0, v6, vcc
v_sub_u32 v14, v6, v10
v_cndmask_b32 v11, 0, v7, vcc
v_sub_u32 v15, v7, v11
v_mov_b32 v132, 0x3f803f80
v_mov_b32 v133, 0x3f803f80
v_mov_b32 v134, 0x3f803f80
v_mov_b32 v135, 0x3f803f80
v_mov_b32 v136, 0x3f803f80
v_mov_b32 v137, 0x3f803f80
v_mov_b32 v138, 0x3f803f80
v_mov_b32 v139, 0x3f803f80
v_mov_b32 v208, 0x44444444
v_mov_b32 v212, 0xeeeeeeee
v_cndmask_b32 v208, v208, v212, s[50:51]
v_and_b32 v212, 13, v210
v_cmp_eq_u32 vcc, 8, v212
s_nop 1
v_cndmask_b32 v76, 0, v132, vcc
v_cndmask_b32 v77, 0, v132, vcc
v_cndmask_b32 v78, 0, v132, vcc
v_cndmask_b32 v79, 0, v132, vcc
ds_write_b128 v194, v[76:79] offset:0
ds_write_b128 v194, v[76:79] offset:1056
s_waitcnt vmcnt(7)
s_waitcnt lgkmcnt(0)
s_mul_i32 s26, s26, 0x9e3779b1
s_add_u32 s26, s26, 0x7f4a7c15
s_xor_b32 s92, s26, s54
v_mov_b32 v162, s92
s_mov_b64 exec, 1
global_store_dword v180, v162, s[28:29] sc1
s_mov_b64 exec, -1
global_load_dword v218, v178, s[38:39] sc1
s_waitcnt vmcnt(11)
v_mov_b64 v[142:143], 0
v_dot2_f32_bf16 v142, v20, v20, v142
v_dot2_f32_bf16 v143, v20, v132, v143
v_dot2_f32_bf16 v142, v21, v21, v142
v_dot2_f32_bf16 v143, v21, v132, v143
v_dot2_f32_bf16 v142, v22, v22, v142
v_dot2_f32_bf16 v143, v22, v132, v143
v_dot2_f32_bf16 v142, v23, v23, v142
v_dot2_f32_bf16 v143, v23, v132, v143
v_dot2_f32_bf16 v142, v24, v24, v142
v_dot2_f32_bf16 v143, v24, v132, v143
v_dot2_f32_bf16 v142, v25, v25, v142
v_dot2_f32_bf16 v143, v25, v132, v143
v_dot2_f32_bf16 v142, v26, v26, v142
v_dot2_f32_bf16 v143, v26, v132, v143
v_dot2_f32_bf16 v142, v27, v27, v142
v_dot2_f32_bf16 v143, v27, v132, v143
v_lshlrev_b32 v124, 16, v140
v_and_b32 v125, 0xffff0000, v140
v_lshlrev_b32 v126, 16, v141
v_and_b32 v127, 0xffff0000, v141
v_add_f32_dpp v142, v142, v142 row_ror:1 row_mask:0xf bank_mask:0xf
v_add_f32_dpp v143, v143, v143 row_ror:1 row_mask:0xf bank_mask:0xf
s_nop 0
v_add_f32_dpp v142, v142, v142 row_ror:2 row_mask:0xf bank_mask:0xf
v_add_f32_dpp v143, v143, v143 row_ror:2 row_mask:0xf bank_mask:0xf
s_nop 0
v_add_f32_dpp v142, v142, v142 row_ror:4 row_mask:0xf bank_mask:0xf
v_add_f32_dpp v143, v143, v143 row_ror:4 row_mask:0xf bank_mask:0xf
s_nop 0
v_add_f32_dpp v142, v142, v142 row_ror:8 row_mask:0xf bank_mask:0xf
v_add_f32_dpp v143, v143, v143 row_ror:8 row_mask:0xf bank_mask:0xf
v_mov_b64 v[164:165], v[142:143]
s_nop 1
v_permlane16_swap_b32 v164, v142
v_permlane16_swap_b32 v165, v143
v_pk_add_f32 v[142:143], v[142:143], v[164:165]
v_mov_b64 v[164:165], v[142:143]
s_nop 1
v_permlane32_swap_b32 v164, v142
v_permlane32_swap_b32 v165, v143
v_pk_add_f32 v[142:143], v[142:143], v[164:165]
v_mul_f32 v145, 0xba800000, v143
v_mul_f32 v212, v145, v145
v_mul_f32 v213, 0x3a800000, v142
v_sub_f32 v213, v213, v212
v_max_f32 v213, 0, v213
v_add_f32 v213, 0x3727c5ac, v213
v_rsq_f32 v213, v213
s_nop 0
v_mul_f32 v213, 0x3e800000, v213
v_add_f32 v40, v124, v145
v_mul_f32 v40, v40, v213
v_mul_f32 v124, 0x3e800000, v124
v_add_f32 v41, v125, v145
v_mul_f32 v41, v41, v213
v_mul_f32 v125, 0x3e800000, v125
v_add_f32 v42, v126, v145
v_mul_f32 v42, v42, v213
v_mul_f32 v126, 0x3e800000, v126
v_add_f32 v43, v127, v145
v_mul_f32 v43, v43, v213
v_mul_f32 v127, 0x3e800000, v127
v_mov_b32 v144, 0x3e0293ee
v_mov_b64 v[44:45], 0
v_mov_b64 v[46:47], 0
v_mov_b64 v[48:49], 0
v_mov_b64 v[50:51], 0
v_mov_b64 v[52:53], 0
v_mov_b64 v[54:55], 0
v_mov_b64 v[56:57], 0
v_mov_b64 v[58:59], 0
s_waitcnt vmcnt(8)
s_add_u32 m0, s44, 106040
v_add_u32 v187, 458752, v183
global_load_lds_dwordx4 v187, s[10:11] nt
s_waitcnt vmcnt(8)
s_add_u32 m0, s44, 110144
v_add_u32 v187, 524288, v183
global_load_lds_dwordx4 v187, s[10:11] nt
s_waitcnt vmcnt(8)
s_add_u32 m0, s44, 114248
v_add_u32 v187, 589824, v183
global_load_lds_dwordx4 v187, s[10:11] nt
s_waitcnt vmcnt(8)
s_add_u32 m0, s44, 118352
v_add_u32 v187, 655360, v183
global_load_lds_dwordx4 v187, s[10:11] nt
s_waitcnt vmcnt(8)
s_add_u32 m0, s44, 122456
v_add_u32 v187, 720896, v183
global_load_lds_dwordx4 v187, s[10:11] nt
s_waitcnt vmcnt(8)
s_add_u32 m0, s44, 126560
v_add_u32 v187, 786432, v183
global_load_lds_dwordx4 v187, s[10:11] nt
s_waitcnt vmcnt(8)
s_add_u32 m0, s44, 130664
v_add_u32 v187, 851968, v183
global_load_lds_dwordx4 v187, s[10:11] nt
s_waitcnt vmcnt(6)
s_add_u32 m0, s44, 134768
v_add_u32 v187, 917504, v183
global_load_lds_dwordx4 v187, s[10:11] nt
s_waitcnt vmcnt(7)
s_waitcnt lgkmcnt(0)
s_barrier
ds_read_b64_tr_b16 a[0:1], v204 offset:0
ds_read_b64_tr_b16 a[2:3], v204 offset:2048
ds_read_b64_tr_b16 a[16:17], v205 offset:0
ds_read_b64_tr_b16 a[18:19], v205 offset:2048
ds_read_b64_tr_b16 a[32:33], v204 offset:8
ds_read_b64_tr_b16 a[34:35], v204 offset:2056
ds_read_b64_tr_b16 a[48:49], v205 offset:8
ds_read_b64_tr_b16 a[50:51], v205 offset:2056
ds_read_b64_tr_b16 a[4:5], v204 offset:16416
ds_read_b64_tr_b16 a[6:7], v204 offset:18464
ds_read_b64_tr_b16 a[20:21], v205 offset:16416
ds_read_b64_tr_b16 a[22:23], v205 offset:18464
ds_read_b64_tr_b16 a[36:37], v204 offset:16424
ds_read_b64_tr_b16 a[38:39], v204 offset:18472
ds_read_b64_tr_b16 a[52:53], v205 offset:16424
ds_read_b64_tr_b16 a[54:55], v205 offset:18472
s_waitcnt vmcnt(6)
s_add_u32 m0, s44, 138872
v_add_u32 v187, 983040, v183
global_load_lds_dwordx4 v187, s[10:11] nt
s_waitcnt vmcnt(6)
s_add_u32 m0, s3, 11264
s_nop 0
global_load_lds_dwordx4 v184, s[6:7] offset:0 nt
s_waitcnt vmcnt(6)
v_xor_b32 v187, 32, v184
global_load_lds_dwordx4 v187, s[6:7] offset:1024 nt
s_waitcnt vmcnt(6)
v_xor_b32 v187, 64, v184
global_load_lds_dwordx4 v187, s[6:7] offset:2048 nt
global_load_dwordx4 v[128:131], v179, s[28:29] sc1
s_waitcnt vmcnt(8)
s_waitcnt lgkmcnt(0)
s_barrier
ds_read_b64_tr_b16 a[8:9], v204 offset:32832
ds_read_b64_tr_b16 a[10:11], v204 offset:34880
ds_read_b64_tr_b16 a[24:25], v205 offset:32832
ds_read_b64_tr_b16 a[26:27], v205 offset:34880
ds_read_b64_tr_b16 a[40:41], v204 offset:32840
ds_read_b64_tr_b16 a[42:43], v204 offset:34888
ds_read_b64_tr_b16 a[56:57], v205 offset:32840
ds_read_b64_tr_b16 a[58:59], v205 offset:34888
s_waitcnt vmcnt(7)
v_xor_b32 v187, 96, v184
global_load_lds_dwordx4 v187, s[6:7] offset:3072 nt
s_waitcnt vmcnt(7)
s_add_u32 m0, s3, 15360
v_xor_b32 v187, 128, v184
v_add_u32 v187, 4096, v187
global_load_lds_dwordx4 v187, s[6:7] offset:0 nt
s_waitcnt vmcnt(7)
v_xor_b32 v187, 160, v184
v_add_u32 v187, 4096, v187
global_load_lds_dwordx4 v187, s[6:7] offset:1024 nt
s_waitcnt vmcnt(7)
v_xor_b32 v187, 192, v184
v_add_u32 v187, 4096, v187
global_load_lds_dwordx4 v187, s[6:7] offset:2048 nt
s_waitcnt vmcnt(8)
s_waitcnt lgkmcnt(0)
s_barrier
ds_read_b64_tr_b16 a[12:13], v204 offset:49248
ds_read_b64_tr_b16 a[14:15], v204 offset:51296
ds_read_b64_tr_b16 a[28:29], v205 offset:49248
ds_read_b64_tr_b16 a[30:31], v205 offset:51296
ds_read_b64_tr_b16 a[44:45], v204 offset:49256
ds_read_b64_tr_b16 a[46:47], v204 offset:51304
ds_read_b64_tr_b16 a[60:61], v205 offset:49256
ds_read_b64_tr_b16 a[62:63], v205 offset:51304
v_cvt_pk_bf16_f32 v140, v40, v41
v_cvt_pk_bf16_f32 v141, v42, v43
ds_write2_b32 v189, v140, v141 offset0:0 offset1:8
v_xor_b32 v187, 224, v184
v_add_u32 v187, 4096, v187
global_load_lds_dwordx4 v187, s[6:7] offset:3072 nt
s_waitcnt lgkmcnt(0)
s_barrier
ds_read_b128 v[84:87], v194 offset:0
ds_read_b128 v[88:91], v194 offset:1056
s_add_u32 m0, s45, 44032
s_nop 0
global_load_lds_dwordx4 v185, s[8:9] offset:0 nt
s_waitcnt lgkmcnt(1)
v_smfmac_f32_16x16x64_bf16 v[44:47], v[84:87], a[0:7], v208
v_smfmac_f32_16x16x64_bf16 v[48:51], v[84:87], a[16:23], v208
s_add_u32 m0, s45, 44040
s_nop 0
global_load_lds_dwordx4 v185, s[8:9] offset:1024 nt
s_waitcnt lgkmcnt(0)
v_smfmac_f32_16x16x64_bf16 v[44:47], v[88:91], a[8:15], v208
v_smfmac_f32_16x16x64_bf16 v[48:51], v[88:91], a[24:31], v208
v_smfmac_f32_16x16x64_bf16 v[52:55], v[84:87], a[32:39], v208
s_nop 5
v_add_f32 v146, v44, v46
v_smfmac_f32_16x16x64_bf16 v[56:59], v[84:87], a[48:55], v208
v_add_f32 v147, v45, v47
v_smfmac_f32_16x16x64_bf16 v[52:55], v[88:91], a[40:47], v208
v_add_f32 v146, v146, v147
v_smfmac_f32_16x16x64_bf16 v[56:59], v[88:91], a[56:63], v208
v_add_f32 v148, v48, v50
v_add_f32 v149, v49, v51
v_add_f32 v148, v148, v149
s_nop 2
v_pk_add_f32 v[150:151], v[52:53], v[54:55]
v_permlane16_swap_b32 v146, v148
v_pk_add_f32 v[152:153], v[56:57], v[58:59]
v_add_f32 v150, v150, v151
v_add_f32 v152, v152, v153
v_add_f32 v146, v146, v148
s_mov_b32 exec_hi, 0
v_permlane16_swap_b32 v150, v152
v_add_f32 v150, v150, v152
v_cvt_pk_bf16_f32 v217, v146, v150
global_store_dword v172, v217, s[38:39]
s_mov_b32 exec_hi, -1
ds_write_b128 v192, v[124:127]
s_add_u32 s57, s26, 1
v_mov_b32 v223, s57
s_waitcnt vmcnt(8)
L_fc_A:
v_xor_b32 v212, s26, v128
v_and_b32 v213, 0xfffffff, v212
s_mov_b32 exec_hi, 0
v_cmp_ne_u32 vcc, 0, v213
s_mov_b32 exec_hi, -1
s_cbranch_vccnz L_fr_A
v_cmp_ne_u32 s[60:61], s54, v212
v_cmp_eq_u32 vcc, s26, v130
s_nop 1
v_cndmask_b32 v213, 0, v131, vcc
v_cmp_lt_i32 s[58:59], 0, v213
v_cmp_gt_i32 vcc, 0, v213
v_mov_b32 v160, s60
s_nop 1
s_bcnt1_i32_b64 s58, s[58:59]
s_bcnt1_i32_b64 s59, vcc
s_sub_u32 s58, s58, s59
v_mov_b32 v161, s58
ds_write_b64 v203, v[160:161]
s_waitcnt lgkmcnt(0)
s_barrier
v_mov_b32 v214, 8608
ds_read_b128 v[100:103], v214
ds_read_b128 v[104:107], v214 offset:16
s_waitcnt lgkmcnt(0)
v_or3_b32 v214, v100, v102, v104
v_add3_u32 v215, v101, v103, v105
v_or_b32 v214, v214, v106
v_add_u32 v215, v215, v107
v_readfirstlane_b32 s37, v214
v_readfirstlane_b32 s72, v215
s_cmp_gt_i32 s72, 0
s_cselect_b32 s57, 1, 0
s_xor_b32 s57, s57, s55
s_lshl_b32 s57, s57, 13
s_add_u32 s42, s28, s57
s_addc_u32 s43, s29, 0
s_cmp_lg_u32 s37, 0
s_cbranch_scc1 L_post_A1
L_post_A0:
s_waitcnt vmcnt(7)
s_add_u32 m0, s45, 44048
s_nop 0
global_load_lds_dwordx4 v185, s[8:9] offset:2048 nt
s_waitcnt vmcnt(7)
s_add_u32 m0, s45, 44056
s_nop 0
global_load_lds_dwordx4 v185, s[8:9] offset:3072 nt
s_waitcnt vmcnt(7)
s_add_u32 m0, s45, 48160
v_add_u32 v187, 4096, v185
global_load_lds_dwordx4 v187, s[8:9] offset:0 nt
s_waitcnt vmcnt(7)
s_add_u32 m0, s45, 48168
v_add_u32 v187, 4096, v185
global_load_lds_dwordx4 v187, s[8:9] offset:1024 nt
s_waitcnt vmcnt(7)
s_add_u32 m0, s45, 48176
v_add_u32 v187, 4096, v185
global_load_lds_dwordx4 v187, s[8:9] offset:2048 nt
s_waitcnt vmcnt(7)
s_add_u32 m0, s45, 48184
v_add_u32 v187, 4096, v185
global_load_lds_dwordx4 v187, s[8:9] offset:3072 nt
s_waitcnt vmcnt(7)
s_add_u32 m0, s44, 77312
s_nop 0
global_load_lds_dwordx4 v186, s[12:13] nt
s_waitcnt vmcnt(6)
s_add_u32 m0, s44, 81416
v_add_u32 v187, 16384, v186
global_load_lds_dwordx4 v187, s[12:13] nt
s_waitcnt vmcnt(6)
s_add_u32 m0, s44, 85520
v_add_u32 v187, 32768, v186
global_load_lds_dwordx4 v187, s[12:13] nt
global_load_dwordx4 v[20:23], v167, s[38:39] sc1
global_load_dwordx4 v[24:27], v167, s[38:39] offset:1024 sc1
global_load_dwordx4 v[28:31], v167, s[38:39] offset:2048 sc1
global_load_dwordx4 v[32:35], v167, s[38:39] offset:3072 sc1
s_waitcnt vmcnt(10)
s_add_u32 m0, s44, 89624
v_add_u32 v187, 49152, v186
global_load_lds_dwordx4 v187, s[12:13] nt
s_waitcnt vmcnt(10)
s_add_u32 m0, s44, 93728
v_add_u32 v187, 65536, v186
global_load_lds_dwordx4 v187, s[12:13] nt
s_waitcnt vmcnt(10)
s_add_u32 m0, s44, 97832
v_add_u32 v187, 81920, v186
global_load_lds_dwordx4 v187, s[12:13] nt
s_waitcnt vmcnt(10)
s_add_u32 m0, s44, 101936
v_add_u32 v187, 98304, v186
global_load_lds_dwordx4 v187, s[12:13] nt
s_waitcnt vmcnt(10)
s_add_u32 m0, s44, 106040
v_add_u32 v187, 114688, v186
global_load_lds_dwordx4 v187, s[12:13] nt
s_waitcnt vmcnt(21)
v_xor_b32 v187, 0, v207
ds_read_b128 a[64:67], v187 offset:0
ds_read_b128 a[80:83], v187 offset:256
v_xor_b32 v187, 64, v207
ds_read_b128 a[68:71], v187 offset:0
ds_read_b128 a[84:87], v187 offset:256
v_xor_b32 v187, 128, v207
ds_read_b128 a[72:75], v187 offset:0
ds_read_b128 a[88:91], v187 offset:256
v_xor_b32 v187, 192, v207
ds_read_b128 a[76:79], v187 offset:0
ds_read_b128 a[92:95], v187 offset:256
s_waitcnt vmcnt(12)
s_waitcnt lgkmcnt(0)
s_barrier
ds_read_b64_tr_b16 a[96:97], v206 offset:0
ds_read_b64_tr_b16 a[98:99], v206 offset:512
ds_read_b64_tr_b16 a[100:101], v206 offset:4128
ds_read_b64_tr_b16 a[102:103], v206 offset:4640
ds_read_b64_tr_b16 a[112:113], v206 offset:8
ds_read_b64_tr_b16 a[114:115], v206 offset:520
ds_read_b64_tr_b16 a[116:117], v206 offset:4136
ds_read_b64_tr_b16 a[118:119], v206 offset:4648
ds_read_b64_tr_b16 a[104:105], v206 offset:16640
ds_read_b64_tr_b16 a[106:107], v206 offset:17152
ds_read_b64_tr_b16 a[108:109], v206 offset:20768
ds_read_b64_tr_b16 a[110:111], v206 offset:21280
ds_read_b64_tr_b16 a[120:121], v206 offset:16648
ds_read_b64_tr_b16 a[122:123], v206 offset:17160
ds_read_b64_tr_b16 a[124:125], v206 offset:20776
ds_read_b64_tr_b16 a[126:127], v206 offset:21288
v_mov_b64 v[44:45], 0
v_mov_b64 v[46:47], 0
v_mov_b64 v[48:49], 0
v_mov_b64 v[50:51], 0
v_mov_b64 v[52:53], 0
v_mov_b64 v[54:55], 0
v_mov_b64 v[56:57], 0
v_mov_b64 v[58:59], 0
v_mov_b64 v[68:69], 0
v_mov_b64 v[70:71], 0
v_mov_b64 v[72:73], 0
v_mov_b64 v[74:75], 0
v_mov_b64 v[60:61], 0
v_mov_b64 v[62:63], 0
v_mov_b64 v[64:65], 0
v_mov_b64 v[66:67], 0
s_branch L_c0_A0
L_r0_A0:
s_sleep 0
s_add_u32 s15, s15, 1
s_cmp_lt_u32 s15, 100000
s_cbranch_scc0 L_fail
global_load_dwordx4 v[20:23], v167, s[38:39] sc1
global_load_dwordx4 v[24:27], v167, s[38:39] offset:1024 sc1
global_load_dwordx4 v[28:31], v167, s[38:39] offset:2048 sc1
global_load_dwordx4 v[32:35], v167, s[38:39] offset:3072 sc1
s_waitcnt vmcnt(0)
L_c0_A0:
s_waitcnt vmcnt(8)
v_mfma_f32_16x16x32_bf16 v[40:43], v[8:11], v[20:23], 0
v_max3_u32 v218, v20, v21, v22
v_max_u32 v218, v218, v23
s_waitcnt vmcnt(7)
v_mfma_f32_16x16x32_bf16 v[40:43], v[8:11], v[24:27], v[40:43]
v_max3_u32 v218, v218, v24, v25
v_max3_u32 v218, v218, v26, v27
s_waitcnt vmcnt(6)
v_mfma_f32_16x16x32_bf16 v[40:43], v[12:15], v[28:31], v[40:43]
v_max3_u32 v218, v218, v28, v29
v_max3_u32 v218, v218, v30, v31
s_waitcnt vmcnt(5)
v_mfma_f32_16x16x32_bf16 v[40:43], v[12:15], v[32:35], v[40:43]
v_max3_u32 v218, v218, v32, v33
v_max3_u32 v218, v218, v34, v35
v_cmp_eq_u32 vcc, -1, v218
s_cbranch_vccnz L_r0_A0
s_nop 3
v_cvt_pk_bf16_f32 v140, v40, v41
v_cvt_pk_bf16_f32 v141, v42, v43
ds_write2_b32 v190, v140, v141 offset0:0 offset1:8
s_add_u32 m0, s44, 110144
v_add_u32 v187, 131072, v186
global_load_lds_dwordx4 v187, s[12:13] nt
s_waitcnt lgkmcnt(0)
s_barrier
ds_read_b128 v[84:87], v194 offset:2112
ds_read_b128 v[88:91], v194 offset:3168
s_add_u32 m0, s44, 114248
v_add_u32 v187, 147456, v186
global_load_lds_dwordx4 v187, s[12:13] nt
s_waitcnt lgkmcnt(1)
v_smfmac_f32_16x16x64_bf16 v[60:63], v[84:87], a[64:71], v208
v_smfmac_f32_16x16x64_bf16 v[64:67], v[84:87], a[80:87], v208
s_add_u32 m0, s44, 118352
v_add_u32 v187, 163840, v186
global_load_lds_dwordx4 v187, s[12:13] nt
s_waitcnt lgkmcnt(0)
v_smfmac_f32_16x16x64_bf16 v[60:63], v[88:91], a[72:79], v208
v_smfmac_f32_16x16x64_bf16 v[64:67], v[88:91], a[88:95], v208
s_add_u32 m0, s44, 122456
v_add_u32 v187, 180224, v186
global_load_lds_dwordx4 v187, s[12:13] nt
s_nop 3
v_pk_add_f32 v[146:147], v[60:61], v[62:63]
v_pk_add_f32 v[148:149], v[64:65], v[66:67]
v_max_f32 v164, v146, v148
v_max_f32 v165, v147, v149
s_nop 0
v_max_f32_dpp v164, v164, v164 row_ror:1 row_mask:0xf bank_mask:0xf
v_max_f32_dpp v165, v165, v165 row_ror:1 row_mask:0xf bank_mask:0xf
s_nop 0
v_max_f32_dpp v164, v164, v164 row_ror:2 row_mask:0xf bank_mask:0xf
v_max_f32_dpp v165, v165, v165 row_ror:2 row_mask:0xf bank_mask:0xf
s_nop 0
v_max_f32_dpp v164, v164, v164 row_ror:4 row_mask:0xf bank_mask:0xf
v_max_f32_dpp v165, v165, v165 row_ror:4 row_mask:0xf bank_mask:0xf
s_nop 0
v_max_f32_dpp v164, v164, v164 row_ror:8 row_mask:0xf bank_mask:0xf
v_max_f32_dpp v165, v165, v165 row_ror:8 row_mask:0xf bank_mask:0xf
v_pk_mul_f32 v[164:165], v[164:165], v[144:145] op_sel_hi:[1,0]
v_ceil_f32 v164, v164
v_ceil_f32 v165, v165
v_pk_fma_f32 v[146:147], v[146:147], v[144:145], v[164:165] op_sel_hi:[1,0,1] neg_lo:[0,0,1] neg_hi:[0,0,1]
v_pk_fma_f32 v[148:149], v[148:149], v[144:145], v[164:165] op_sel_hi:[1,0,1] neg_lo:[0,0,1] neg_hi:[0,0,1]
v_exp_f32 v146, v146
v_exp_f32 v148, v148
v_exp_f32 v147, v147
v_exp_f32 v149, v149
v_cvt_pk_bf16_f32 v212, v146, v148
ds_write_b64 v198, v[164:165]
v_cvt_pk_bf16_f32 v213, v147, v149
ds_write2_b32 v197, v212, v213 offset0:0 offset1:4
s_waitcnt lgkmcnt(0)
s_barrier
ds_read_b128 v[84:87], v196 offset:6336
ds_read_b128 v[92:95], v199
ds_read_b128 v[96:99], v199 offset:16
ds_read_b128 v[88:91], v196 offset:7392
s_waitcnt lgkmcnt(3)
v_smfmac_f32_16x16x64_bf16 v[44:47], v[84:87], a[96:103], v208
s_waitcnt lgkmcnt(1)
v_max3_f32 v120, v92, v94, v96
v_max3_f32 v121, v93, v95, v97
v_smfmac_f32_16x16x64_bf16 v[48:51], v[84:87], a[112:119], v208
v_max_f32 v120, v120, v98
v_max_f32 v121, v121, v99
s_waitcnt lgkmcnt(0)
v_smfmac_f32_16x16x64_bf16 v[52:55], v[88:91], a[104:111], v208
v_sub_f32 v92, v92, v120
v_sub_f32 v93, v93, v121
v_smfmac_f32_16x16x64_bf16 v[56:59], v[88:91], a[120:127], v208
v_sub_f32 v94, v94, v120
v_sub_f32 v95, v95, v121
v_smfmac_f32_16x16x64_bf16 v[68:71], v[84:87], v[132:139], v208
v_sub_f32 v96, v96, v120
v_sub_f32 v97, v97, v121
v_smfmac_f32_16x16x64_bf16 v[72:75], v[88:91], v[132:139], v208
v_sub_f32 v98, v98, v120
v_sub_f32 v99, v99, v121
v_exp_f32 v92, v92
v_exp_f32 v93, v93
v_exp_f32 v94, v94
v_exp_f32 v95, v95
v_exp_f32 v96, v96
v_exp_f32 v97, v97
v_exp_f32 v98, v98
v_exp_f32 v99, v99
v_pk_mul_f32 v[146:147], v[44:45], v[92:93]
v_pk_mul_f32 v[148:149], v[48:49], v[92:93]
v_pk_fma_f32 v[146:147], v[46:47], v[94:95], v[146:147]
v_pk_fma_f32 v[148:149], v[50:51], v[94:95], v[148:149]
v_pk_fma_f32 v[146:147], v[52:53], v[96:97], v[146:147]
v_pk_fma_f32 v[148:149], v[56:57], v[96:97], v[148:149]
v_pk_fma_f32 v[146:147], v[54:55], v[98:99], v[146:147]
v_pk_fma_f32 v[148:149], v[58:59], v[98:99], v[148:149]
v_cvt_pk_bf16_f32 v212, v146, v148
v_cvt_pk_bf16_f32 v213, v147, v149
global_store_dword v174, v212, s[38:39]
v_pk_mul_f32 v[122:123], v[68:69], v[92:93]
v_pk_fma_f32 v[122:123], v[70:71], v[94:95], v[122:123]
global_store_dword v174, v213, s[38:39] offset:256
v_pk_fma_f32 v[122:123], v[72:73], v[96:97], v[122:123]
v_pk_fma_f32 v[122:123], v[74:75], v[98:99], v[122:123]
s_mov_b64 exec, s[48:49]
global_store_dwordx4 v175, v[120:123], s[38:39]
s_mov_b64 exec, -1
v_add_u32 v214, 1056, v193
ds_read2_b32 v[100:101], v193 offset0:0 offset1:4
ds_read2_b32 v[102:103], v193 offset0:132 offset1:136
ds_read2_b32 v[104:105], v214 offset0:0 offset1:4
ds_read2_b32 v[106:107], v214 offset0:132 offset1:136
v_mov_b64 v[44:45], 0
v_mov_b64 v[46:47], 0
v_mov_b64 v[48:49], 0
v_mov_b64 v[50:51], 0
v_mov_b64 v[52:53], 0
v_mov_b64 v[54:55], 0
v_mov_b64 v[56:57], 0
v_mov_b64 v[58:59], 0
s_waitcnt lgkmcnt(0)
v_pk_add_f32 v[100:101], v[100:101], v[102:103]
v_pk_add_f32 v[104:105], v[104:105], v[106:107]
v_pk_add_f32 v[100:101], v[100:101], v[104:105]
v_cvt_pk_bf16_f32 v214, v100, v101
v_lshlrev_b32 v158, 16, v214
v_and_b32 v159, 0xffff0000, v214
v_mul_f32 v158, s46, v158
v_mul_f32 v159, s46, v159
s_waitcnt vmcnt(9)
s_add_u32 m0, s44, 126560
v_add_u32 v187, 196608, v186
global_load_lds_dwordx4 v187, s[12:13] nt
s_waitcnt vmcnt(9)
s_add_u32 m0, s44, 130664
v_add_u32 v187, 212992, v186
global_load_lds_dwordx4 v187, s[12:13] nt
s_waitcnt vmcnt(9)
s_add_u32 m0, s44, 134768
v_add_u32 v187, 229376, v186
global_load_lds_dwordx4 v187, s[12:13] nt
s_waitcnt vmcnt(9)
s_add_u32 m0, s44, 138872
v_add_u32 v187, 245760, v186
global_load_lds_dwordx4 v187, s[12:13] nt
s_waitcnt vmcnt(11)
s_waitcnt lgkmcnt(0)
s_barrier
ds_read_b64_tr_b16 a[128:129], v204 offset:0
ds_read_b64_tr_b16 a[130:131], v204 offset:2048
ds_read_b64_tr_b16 a[144:145], v205 offset:0
ds_read_b64_tr_b16 a[146:147], v205 offset:2048
ds_read_b64_tr_b16 a[160:161], v204 offset:8
ds_read_b64_tr_b16 a[162:163], v204 offset:2056
ds_read_b64_tr_b16 a[176:177], v205 offset:8
ds_read_b64_tr_b16 a[178:179], v205 offset:2056
ds_read_b64_tr_b16 a[132:133], v204 offset:16416
ds_read_b64_tr_b16 a[134:135], v204 offset:18464
ds_read_b64_tr_b16 a[148:149], v205 offset:16416
ds_read_b64_tr_b16 a[150:151], v205 offset:18464
ds_read_b64_tr_b16 a[164:165], v204 offset:16424
ds_read_b64_tr_b16 a[166:167], v204 offset:18472
ds_read_b64_tr_b16 a[180:181], v205 offset:16424
ds_read_b64_tr_b16 a[182:183], v205 offset:18472
global_load_dwordx3 v[36:38], v171, s[38:39] sc1
global_load_dwordx4 v[20:23], v170, s[38:39] sc1
global_load_dwordx4 v[24:27], v170, s[38:39] offset:2048 sc1
s_waitcnt vmcnt(10)
s_waitcnt lgkmcnt(0)
s_barrier
ds_read_b64_tr_b16 a[136:137], v204 offset:32832
ds_read_b64_tr_b16 a[138:139], v204 offset:34880
ds_read_b64_tr_b16 a[152:153], v205 offset:32832
ds_read_b64_tr_b16 a[154:155], v205 offset:34880
ds_read_b64_tr_b16 a[168:169], v204 offset:32840
ds_read_b64_tr_b16 a[170:171], v204 offset:34888
ds_read_b64_tr_b16 a[184:185], v205 offset:32840
ds_read_b64_tr_b16 a[186:187], v205 offset:34888
s_waitcnt vmcnt(3)
s_waitcnt lgkmcnt(0)
s_barrier
ds_read_b64_tr_b16 a[140:141], v204 offset:49248
ds_read_b64_tr_b16 a[142:143], v204 offset:51296
ds_read_b64_tr_b16 a[156:157], v205 offset:49248
ds_read_b64_tr_b16 a[158:159], v205 offset:51296
ds_read_b64_tr_b16 a[172:173], v204 offset:49256
ds_read_b64_tr_b16 a[174:175], v204 offset:51304
ds_read_b64_tr_b16 a[188:189], v205 offset:49256
ds_read_b64_tr_b16 a[190:191], v205 offset:51304
s_branch L_c1_A0
L_r1_A0:
s_sleep 0
s_add_u32 s15, s15, 1
s_cmp_lt_u32 s15, 100000
s_cbranch_scc0 L_fail
global_load_dwordx3 v[36:38], v171, s[38:39] sc1
global_load_dwordx4 v[20:23], v170, s[38:39] sc1
global_load_dwordx4 v[24:27], v170, s[38:39] offset:2048 sc1
s_waitcnt vmcnt(0)
L_c1_A0:
s_waitcnt vmcnt(2)
v_max_f32_dpp v142, v36, v36 quad_perm:[1,0,3,2] row_mask:0xf bank_mask:0xf
v_max_u32 v218, v36, v38
s_nop 0
v_max_f32_dpp v142, v142, v142 quad_perm:[2,3,0,1] row_mask:0xf bank_mask:0xf
s_nop 1
v_max_f32_dpp v142, v142, v142 row_half_mirror row_mask:0xf bank_mask:0xf
s_nop 1
v_subrev_f32_dpp v212, v142, v36 row_newbcast:0 row_mask:0xf bank_mask:0xf
v_exp_f32 v212, v212
s_waitcnt vmcnt(1)
v_max3_u32 v218, v218, v20, v21
v_max3_u32 v218, v218, v22, v23
v_perm_b32 v213, v212, v212, s56
v_mul_f32 v143, v212, v38
s_nop 0
v_and_b32_dpp v84, v213, v16 row_newbcast:8 row_mask:0xf bank_mask:0xf
v_and_b32_dpp v85, v213, v17 row_newbcast:8 row_mask:0xf bank_mask:0xf
v_and_b32_dpp v86, v213, v18 row_newbcast:8 row_mask:0xf bank_mask:0xf
v_and_b32_dpp v87, v213, v19 row_newbcast:8 row_mask:0xf bank_mask:0xf
v_and_b32_dpp v88, v213, v16 row_newbcast:9 row_mask:0xf bank_mask:0xf
v_and_b32_dpp v89, v213, v17 row_newbcast:9 row_mask:0xf bank_mask:0xf
v_mfma_f32_16x16x32_bf16 v[40:43], v[84:87], v[20:23], 0
v_and_b32_dpp v90, v213, v18 row_newbcast:9 row_mask:0xf bank_mask:0xf
v_and_b32_dpp v91, v213, v19 row_newbcast:9 row_mask:0xf bank_mask:0xf
v_add_f32_dpp v143, v143, v143 quad_perm:[1,0,3,2] row_mask:0xf bank_mask:0xf
s_waitcnt vmcnt(0)
v_mfma_f32_16x16x32_bf16 v[40:43], v[88:91], v[24:27], v[40:43]
v_max3_u32 v218, v218, v24, v25
v_max3_u32 v218, v218, v26, v27
v_add_f32_dpp v143, v143, v143 quad_perm:[2,3,0,1] row_mask:0xf bank_mask:0xf
v_cmp_eq_u32 vcc, -1, v218
s_nop 0
v_add_f32_dpp v143, v143, v143 row_half_mirror row_mask:0xf bank_mask:0xf
s_cbranch_vccnz L_r1_A0
s_mov_b64 exec, 1
ds_write_b64 v200, v[142:143]
s_mov_b64 exec, -1
v_cvt_pk_bf16_f32 v140, v40, v41
v_cvt_pk_bf16_f32 v141, v42, v43
ds_write2_b32 v191, v140, v141 offset0:0 offset1:8
s_waitcnt lgkmcnt(0)
s_barrier
ds_read_b128 v[84:87], v194 offset:4224
ds_read_b128 v[100:103], v201
ds_read_b128 v[104:107], v202
ds_read_b128 v[88:91], v194 offset:5280
s_mov_b64 exec, 3
global_store_dword v181, v223, s[28:29] sc1
s_mov_b64 exec, -1
s_waitcnt lgkmcnt(3)
v_smfmac_f32_16x16x64_bf16 v[44:47], v[84:87], a[128:135], v208
s_waitcnt lgkmcnt(1)
v_max3_f32 v212, v100, v102, v104
v_smfmac_f32_16x16x64_bf16 v[48:51], v[84:87], a[144:151], v208
v_max_f32 v212, v212, v106
v_sub_f32 v92, v100, v212
s_waitcnt lgkmcnt(0)
v_smfmac_f32_16x16x64_bf16 v[44:47], v[88:91], a[136:143], v208
v_sub_f32 v93, v102, v212
v_exp_f32 v92, v92
v_smfmac_f32_16x16x64_bf16 v[48:51], v[88:91], a[152:159], v208
v_sub_f32 v94, v104, v212
v_exp_f32 v93, v93
v_smfmac_f32_16x16x64_bf16 v[52:55], v[84:87], a[160:167], v208
v_sub_f32 v95, v106, v212
v_exp_f32 v94, v94
v_smfmac_f32_16x16x64_bf16 v[56:59], v[84:87], a[176:183], v208
v_mul_f32 v213, v92, v101
v_exp_f32 v95, v95
v_smfmac_f32_16x16x64_bf16 v[52:55], v[88:91], a[168:175], v208
v_fma_f32 v213, v93, v103, v213
v_fma_f32 v213, v94, v105, v213
v_smfmac_f32_16x16x64_bf16 v[56:59], v[88:91], a[184:191], v208
v_fma_f32 v213, v95, v107, v213
v_rcp_f32 v213, v213
v_pk_add_f32 v[146:147], v[44:45], v[46:47]
v_pk_add_f32 v[148:149], v[48:49], v[50:51]
v_mul_f32 v146, v146, v92
v_mul_f32 v148, v148, v92
v_fma_f32 v146, v147, v93, v146
v_fma_f32 v148, v149, v93, v148
v_pk_add_f32 v[150:151], v[52:53], v[54:55]
v_pk_add_f32 v[152:153], v[56:57], v[58:59]
v_permlane16_swap_b32 v146, v148
v_mul_f32 v150, v150, v92
v_mul_f32 v152, v152, v92
v_fma_f32 v150, v151, v93, v150
v_fma_f32 v152, v153, v93, v152
v_add_f32 v146, v146, v148
v_fma_f32 v146, v146, v213, v158
v_permlane16_swap_b32 v150, v152
v_add_f32 v150, v150, v152
v_fma_f32 v150, v150, v213, v159
v_cvt_pk_bf16_f32 v212, v146, v150
global_store_dword v176, v212, s[38:39] sc1
global_load_dwordx4 v[128:131], v179, s[28:29] sc1
global_load_dword v218, v178, s[40:41] sc1
s_waitcnt vmcnt(1)
v_xor_b32 v212, s26, v128
v_cmp_ne_u32 s[60:61], s54, v212
v_cmp_eq_u32 vcc, s26, v130
s_nop 1
v_cndmask_b32 v213, 0, v131, vcc
v_cmp_lt_i32 s[58:59], 0, v213
v_cmp_gt_i32 vcc, 0, v213
v_mov_b32 v160, s60
s_nop 1
s_bcnt1_i32_b64 s58, s[58:59]
s_bcnt1_i32_b64 s59, vcc
s_sub_u32 s58, s58, s59
v_mov_b32 v161, s58
ds_write_b64 v203, v[160:161]
v_mov_b64 v[44:45], 0
v_mov_b64 v[46:47], 0
v_mov_b64 v[48:49], 0
v_mov_b64 v[50:51], 0
v_mov_b64 v[52:53], 0
v_mov_b64 v[54:55], 0
v_mov_b64 v[56:57], 0
v_mov_b64 v[58:59], 0
ds_read_b128 v[84:87], v194 offset:0
ds_read_b128 v[88:91], v194 offset:1056
s_waitcnt lgkmcnt(0)
v_smfmac_f32_16x16x64_bf16 v[44:47], v[84:87], a[0:7], v208
v_smfmac_f32_16x16x64_bf16 v[48:51], v[84:87], a[16:23], v208
s_waitcnt lgkmcnt(0)
v_smfmac_f32_16x16x64_bf16 v[44:47], v[88:91], a[8:15], v208
v_smfmac_f32_16x16x64_bf16 v[48:51], v[88:91], a[24:31], v208
v_smfmac_f32_16x16x64_bf16 v[52:55], v[84:87], a[32:39], v208
v_smfmac_f32_16x16x64_bf16 v[56:59], v[84:87], a[48:55], v208
v_smfmac_f32_16x16x64_bf16 v[52:55], v[88:91], a[40:47], v208
v_smfmac_f32_16x16x64_bf16 v[56:59], v[88:91], a[56:63], v208
s_nop 2
v_pk_add_f32 v[146:147], v[44:45], v[46:47]
v_add_f32 v146, v146, v147
v_pk_add_f32 v[148:149], v[48:49], v[50:51]
v_add_f32 v148, v148, v149
v_pk_add_f32 v[150:151], v[52:53], v[54:55]
v_add_f32 v150, v150, v151
v_pk_add_f32 v[152:153], v[56:57], v[58:59]
v_add_f32 v152, v152, v153
v_permlane16_swap_b32 v146, v148
v_add_f32 v146, v146, v148
v_permlane16_swap_b32 v150, v152
v_add_f32 v150, v150, v152
v_cvt_pk_bf16_f32 v212, v146, v150
s_mov_b32 exec_lo, 0
global_store_dword v172, v212, s[38:39]
s_mov_b32 exec_lo, -1
global_load_dwordx4 v[20:23], v168, s[38:39] sc1
global_load_dwordx4 v[24:27], v168, s[38:39] offset:1024 sc1
global_load_dwordx4 v[28:31], v168, s[40:41] sc1
global_load_dwordx4 v[32:35], v168, s[40:41] offset:1024 sc1
v_mov_b64 v[60:61], 0
v_mov_b64 v[62:63], 0
v_mov_b64 v[64:65], 0
v_mov_b64 v[66:67], 0
L_cc_A0:
s_waitcnt vmcnt(3)
v_mfma_f32_16x16x32_bf16 v[40:43], v[8:11], v[20:23], 0
v_max3_u32 v218, v20, v21, v22
v_max_u32 v218, v218, v23
s_waitcnt vmcnt(2)
v_mfma_f32_16x16x32_bf16 v[40:43], v[8:11], v[24:27], v[40:43]
v_max3_u32 v218, v218, v24, v25
v_max3_u32 v218, v218, v26, v27
s_waitcnt vmcnt(1)
v_mfma_f32_16x16x32_bf16 v[40:43], v[12:15], v[28:31], v[40:43]
v_max3_u32 v218, v218, v28, v29
v_max3_u32 v218, v218, v30, v31
s_waitcnt vmcnt(0)
v_mfma_f32_16x16x32_bf16 v[40:43], v[12:15], v[32:35], v[40:43]
v_max3_u32 v218, v218, v32, v33
v_max3_u32 v218, v218, v34, v35
v_cmp_eq_u32 vcc, -1, v218
s_cbranch_vccnz L_cr_A0
s_nop 3
v_cvt_pk_bf16_f32 v140, v40, v41
v_cvt_pk_bf16_f32 v141, v42, v43
ds_write2_b32 v190, v140, v141 offset0:0 offset1:8
s_waitcnt lgkmcnt(0)
s_barrier
ds_read_b128 v[84:87], v194 offset:2112
ds_read_b128 v[88:91], v194 offset:3168
s_waitcnt lgkmcnt(0)
v_smfmac_f32_16x16x64_bf16 v[60:63], v[84:87], a[64:71], v208
v_smfmac_f32_16x16x64_bf16 v[64:67], v[84:87], a[80:87], v208
v_smfmac_f32_16x16x64_bf16 v[60:63], v[88:91], a[72:79], v208
v_smfmac_f32_16x16x64_bf16 v[64:67], v[88:91], a[88:95], v208
s_nop 6
v_pk_add_f32 v[154:155], v[60:61], v[62:63]
v_pk_add_f32 v[156:157], v[64:65], v[66:67]
v_mov_b32 v214, 8608
ds_read_b128 v[100:103], v214
ds_read_b128 v[104:107], v214 offset:16
s_waitcnt lgkmcnt(0)
v_or3_b32 v214, v100, v102, v104
v_add3_u32 v215, v101, v103, v105
v_or_b32 v214, v214, v106
v_add_u32 v215, v215, v107
v_readfirstlane_b32 s37, v214
v_readfirstlane_b32 s72, v215
s_cmp_gt_i32 s72, 0
s_cselect_b32 s57, 1, 0
s_xor_b32 s57, s57, s55
s_lshl_b32 s57, s57, 13
s_add_u32 s42, s28, s57
s_addc_u32 s43, s29, 0
s_branch L_al_A0
.p2align 6
L_al_A0:
s_add_u32 s47, s26, 2
s_cmp_eq_u32 s30, 0
s_cbranch_scc0 L_db2_A0
s_mov_b64 exec, 15
global_load_dword v219, v182, s[42:43] offset:0 sc1
s_sleep 1
global_load_dword v220, v182, s[42:43] offset:128 sc1
s_sleep 1
global_load_dword v221, v182, s[42:43] offset:256 sc1
s_sleep 1
global_load_dword v222, v182, s[42:43] offset:384 sc1
s_sleep 1
L_dp2_A0:
s_waitcnt vmcnt(3)
v_cmp_ne_u32 vcc, s47, v219
s_cbranch_vccz L_dd2_A0
global_load_dword v219, v182, s[42:43] offset:0 sc1
s_sleep 1
s_waitcnt vmcnt(3)
v_cmp_ne_u32 vcc, s47, v220
s_cbranch_vccz L_dd2_A0
global_load_dword v220, v182, s[42:43] offset:128 sc1
s_sleep 1
s_waitcnt vmcnt(3)
v_cmp_ne_u32 vcc, s47, v221
s_cbranch_vccz L_dd2_A0
global_load_dword v221, v182, s[42:43] offset:256 sc1
s_sleep 1
s_waitcnt vmcnt(3)
v_cmp_ne_u32 vcc, s47, v222
s_cbranch_vccz L_dd2_A0
global_load_dword v222, v182, s[42:43] offset:384 sc1
s_sleep 1
s_add_u32 s15, s15, 1
s_cmp_lt_u32 s15, 100000
s_cbranch_scc1 L_dp2_A0
s_branch L_fail
L_dd2_A0:
s_mov_b64 exec, -1
L_db2_A0:
s_barrier
L_r5_A0:
global_load_dwordx4 v[20:23], v166, s[42:43] sc1
global_load_dwordx4 v[24:27], v166, s[42:43] offset:1024 sc1
s_add_u32 s15, s15, 1
s_cmp_lt_u32 s15, 100000
s_cbranch_scc0 L_fail
v_mov_b64 v[44:45], 0
v_mov_b64 v[46:47], 0
v_mov_b64 v[48:49], 0
v_mov_b64 v[50:51], 0
v_mov_b64 v[52:53], 0
v_mov_b64 v[54:55], 0
v_mov_b64 v[56:57], 0
v_mov_b64 v[58:59], 0
s_waitcnt vmcnt(1)
v_mfma_f32_16x16x32_bf16 v[40:43], v[4:7], v[20:23], 0
v_max3_u32 v218, v20, v21, v22
v_max_u32 v218, v218, v23
s_waitcnt vmcnt(0)
v_mfma_f32_16x16x32_bf16 v[40:43], v[4:7], v[24:27], v[40:43]
v_max3_u32 v218, v218, v24, v25
v_max3_u32 v218, v218, v26, v27
v_cmp_eq_u32 vcc, -1, v218
s_cbranch_vccnz L_r5_A0
s_nop 3
v_cvt_pk_bf16_f32 v140, v40, v41
v_cvt_pk_bf16_f32 v141, v42, v43
ds_write2_b32 v189, v140, v141 offset0:0 offset1:8
s_waitcnt lgkmcnt(0)
s_barrier
ds_read_b128 v[80:83], v195 offset:0
ds_read_b128 v[84:87], v194 offset:0
ds_read_b128 v[88:91], v194 offset:1056
s_waitcnt lgkmcnt(2)
v_mfma_f32_16x16x32_bf16 v[76:79], v[80:83], v[80:83], 0
s_waitcnt lgkmcnt(1)
v_smfmac_f32_16x16x64_bf16 v[44:47], v[84:87], a[0:7], v208
v_smfmac_f32_16x16x64_bf16 v[48:51], v[84:87], a[16:23], v208
s_waitcnt lgkmcnt(0)
v_smfmac_f32_16x16x64_bf16 v[44:47], v[88:91], a[8:15], v208
s_nop 2
v_add_f32 v142, v76, v77
v_add_f32 v143, v78, v79
v_smfmac_f32_16x16x64_bf16 v[48:51], v[88:91], a[24:31], v208
v_cndmask_b32 v142, v142, v143, s[50:51]
v_smfmac_f32_16x16x64_bf16 v[52:55], v[84:87], a[32:39], v208
v_add_f32 v146, v44, v46
v_add_f32_dpp v142, v142, v142 quad_perm:[1,0,3,2] row_mask:0xf bank_mask:0xf
v_smfmac_f32_16x16x64_bf16 v[56:59], v[84:87], a[48:55], v208
v_add_f32 v147, v45, v47
v_add_f32_dpp v142, v142, v142 quad_perm:[2,3,0,1] row_mask:0xf bank_mask:0xf
v_smfmac_f32_16x16x64_bf16 v[52:55], v[88:91], a[40:47], v208
v_add_f32 v146, v146, v147
v_add_f32_dpp v142, v142, v142 row_half_mirror row_mask:0xf bank_mask:0xf
v_smfmac_f32_16x16x64_bf16 v[56:59], v[88:91], a[56:63], v208
v_add_f32 v148, v48, v50
v_add_f32 v149, v49, v51
v_add_f32 v148, v148, v149
s_mov_b64 exec, s[52:53]
global_store_dword v173, v142, s[40:41]
s_mov_b64 exec, -1
v_pk_add_f32 v[150:151], v[52:53], v[54:55]
v_permlane16_swap_b32 v146, v148
v_pk_add_f32 v[152:153], v[56:57], v[58:59]
v_add_f32 v150, v150, v151
v_add_f32 v152, v152, v153
v_add_f32 v146, v146, v148
s_mov_b32 exec_hi, 0
v_permlane16_swap_b32 v150, v152
v_add_f32 v150, v150, v152
v_cvt_pk_bf16_f32 v212, v146, v150
global_store_dword v172, v212, s[40:41]
s_mov_b32 exec_hi, -1
ds_write_b128 v192, v[40:43]
s_add_u32 s57, s26, 3
v_mov_b32 v223, s57
s_sleep 3
L_r6_A0:
global_load_dwordx4 v[20:23], v167, s[40:41] sc1
global_load_dwordx4 v[24:27], v167, s[40:41] offset:1024 sc1
global_load_dwordx4 v[28:31], v167, s[40:41] offset:2048 sc1
global_load_dwordx4 v[32:35], v167, s[40:41] offset:3072 sc1
global_load_dwordx4 v[36:39], v169, s[40:41] sc1
s_add_u32 s15, s15, 1
s_cmp_lt_u32 s15, 100000
s_cbranch_scc0 L_fail
v_mov_b64 v[44:45], 0
v_mov_b64 v[46:47], 0
v_mov_b64 v[48:49], 0
v_mov_b64 v[50:51], 0
v_mov_b64 v[52:53], 0
v_mov_b64 v[54:55], 0
v_mov_b64 v[56:57], 0
v_mov_b64 v[58:59], 0
v_mov_b64 v[68:69], 0
v_mov_b64 v[70:71], 0
v_mov_b64 v[72:73], 0
v_mov_b64 v[74:75], 0
v_mov_b64 v[62:63], 0
v_mov_b64 v[66:67], 0
s_waitcnt vmcnt(4)
v_mfma_f32_16x16x32_bf16 v[40:43], v[8:11], v[20:23], 0
v_max3_u32 v218, v20, v21, v22
v_max_u32 v218, v218, v23
s_waitcnt vmcnt(3)
v_mfma_f32_16x16x32_bf16 v[40:43], v[8:11], v[24:27], v[40:43]
v_max3_u32 v218, v218, v24, v25
v_max3_u32 v218, v218, v26, v27
s_waitcnt vmcnt(2)
v_mfma_f32_16x16x32_bf16 v[40:43], v[12:15], v[28:31], v[40:43]
v_max3_u32 v218, v218, v28, v29
v_max3_u32 v218, v218, v30, v31
s_waitcnt vmcnt(1)
v_mfma_f32_16x16x32_bf16 v[40:43], v[12:15], v[32:35], v[40:43]
v_max3_u32 v218, v218, v32, v33
v_max3_u32 v218, v218, v34, v35
s_waitcnt vmcnt(0)
v_max3_u32 v218, v218, v36, v37
v_max_u32 v218, v218, v38
v_cmp_eq_u32 vcc, -1, v218
s_cbranch_vccnz L_r6_A0
s_nop 0
v_cvt_pk_bf16_f32 v140, v40, v41
v_cvt_pk_bf16_f32 v141, v42, v43
ds_write2_b32 v190, v140, v141 offset0:0 offset1:8
v_add_f32 v142, v36, v37
v_add_f32_dpp v143, v38, v38 row_ror:1 row_mask:0xf bank_mask:0xf
s_nop 0
v_add_f32_dpp v142, v142, v142 row_ror:1 row_mask:0xf bank_mask:0xf
v_add_f32_dpp v143, v143, v143 row_ror:2 row_mask:0xf bank_mask:0xf
s_waitcnt lgkmcnt(0)
s_barrier
ds_read_b128 v[84:87], v194 offset:2112
ds_read_b128 v[88:91], v194 offset:3168
v_add_f32_dpp v142, v142, v142 row_ror:2 row_mask:0xf bank_mask:0xf
v_add_f32_dpp v143, v143, v143 row_ror:4 row_mask:0xf bank_mask:0xf
s_nop 0
v_add_f32_dpp v142, v142, v142 row_ror:4 row_mask:0xf bank_mask:0xf
v_add_f32_dpp v143, v143, v143 row_ror:8 row_mask:0xf bank_mask:0xf
s_nop 0
v_add_f32_dpp v142, v142, v142 row_ror:8 row_mask:0xf bank_mask:0xf
v_mul_f32 v145, 0xba800000, v143
v_pk_mul_f32 v[60:61], v[154:155], v[144:145] op_sel:[0,1] op_sel_hi:[1,1]
v_pk_mul_f32 v[64:65], v[156:157], v[144:145] op_sel:[0,1] op_sel_hi:[1,1]
s_waitcnt lgkmcnt(1)
v_smfmac_f32_16x16x64_bf16 v[60:63], v[84:87], a[64:71], v208
v_mul_f32 v212, v145, v145
v_mul_f32 v213, 0x3a800000, v142
v_smfmac_f32_16x16x64_bf16 v[64:67], v[84:87], a[80:87], v208
v_sub_f32 v213, v213, v212
v_max_f32 v213, 0, v213
s_waitcnt lgkmcnt(0)
v_smfmac_f32_16x16x64_bf16 v[60:63], v[88:91], a[72:79], v208
v_add_f32 v213, 0x3727c5ac, v213
v_rsq_f32 v213, v213
v_smfmac_f32_16x16x64_bf16 v[64:67], v[88:91], a[88:95], v208
v_mul_f32 v144, 0x3e0293ee, v213
s_nop 3
v_pk_add_f32 v[146:147], v[60:61], v[62:63]
s_nop 1
v_pk_add_f32 v[148:149], v[64:65], v[66:67]
v_max_f32 v164, v146, v148
v_max_f32 v165, v147, v149
s_nop 0
v_max_f32_dpp v164, v164, v164 row_ror:1 row_mask:0xf bank_mask:0xf
v_max_f32_dpp v165, v165, v165 row_ror:1 row_mask:0xf bank_mask:0xf
s_nop 0
v_max_f32_dpp v164, v164, v164 row_ror:2 row_mask:0xf bank_mask:0xf
v_max_f32_dpp v165, v165, v165 row_ror:2 row_mask:0xf bank_mask:0xf
s_nop 0
v_max_f32_dpp v164, v164, v164 row_ror:4 row_mask:0xf bank_mask:0xf
v_max_f32_dpp v165, v165, v165 row_ror:4 row_mask:0xf bank_mask:0xf
s_nop 0
v_max_f32_dpp v164, v164, v164 row_ror:8 row_mask:0xf bank_mask:0xf
v_max_f32_dpp v165, v165, v165 row_ror:8 row_mask:0xf bank_mask:0xf
v_pk_mul_f32 v[164:165], v[164:165], v[144:145] op_sel_hi:[1,0]
v_ceil_f32 v164, v164
v_ceil_f32 v165, v165
v_pk_fma_f32 v[146:147], v[146:147], v[144:145], v[164:165] op_sel_hi:[1,0,1] neg_lo:[0,0,1] neg_hi:[0,0,1]
v_pk_fma_f32 v[148:149], v[148:149], v[144:145], v[164:165] op_sel_hi:[1,0,1] neg_lo:[0,0,1] neg_hi:[0,0,1]
v_exp_f32 v146, v146
v_exp_f32 v148, v148
v_exp_f32 v147, v147
v_exp_f32 v149, v149
v_cvt_pk_bf16_f32 v212, v146, v148
ds_write_b64 v198, v[164:165]
v_cvt_pk_bf16_f32 v213, v147, v149
ds_write2_b32 v197, v212, v213 offset0:0 offset1:4
s_waitcnt lgkmcnt(0)
s_barrier
ds_read_b128 v[84:87], v196 offset:6336
ds_read_b128 v[92:95], v199
ds_read_b128 v[96:99], v199 offset:16
ds_read_b128 v[88:91], v196 offset:7392
s_waitcnt lgkmcnt(3)
v_smfmac_f32_16x16x64_bf16 v[44:47], v[84:87], a[96:103], v208
s_waitcnt lgkmcnt(1)
v_max3_f32 v120, v92, v94, v96
v_max3_f32 v121, v93, v95, v97
v_smfmac_f32_16x16x64_bf16 v[48:51], v[84:87], a[112:119], v208
v_max_f32 v120, v120, v98
v_max_f32 v121, v121, v99
s_waitcnt lgkmcnt(0)
v_smfmac_f32_16x16x64_bf16 v[52:55], v[88:91], a[104:111], v208
v_sub_f32 v92, v92, v120
v_sub_f32 v93, v93, v121
v_smfmac_f32_16x16x64_bf16 v[56:59], v[88:91], a[120:127], v208
v_sub_f32 v94, v94, v120
v_sub_f32 v95, v95, v121
v_smfmac_f32_16x16x64_bf16 v[68:71], v[84:87], v[132:139], v208
v_sub_f32 v96, v96, v120
v_sub_f32 v97, v97, v121
v_smfmac_f32_16x16x64_bf16 v[72:75], v[88:91], v[132:139], v208
v_sub_f32 v98, v98, v120
v_sub_f32 v99, v99, v121
v_exp_f32 v92, v92
v_exp_f32 v93, v93
v_exp_f32 v94, v94
v_exp_f32 v95, v95
v_exp_f32 v96, v96
v_exp_f32 v97, v97
v_exp_f32 v98, v98
v_exp_f32 v99, v99
v_pk_mul_f32 v[146:147], v[44:45], v[92:93]
v_pk_mul_f32 v[148:149], v[48:49], v[92:93]
v_pk_fma_f32 v[146:147], v[46:47], v[94:95], v[146:147]
v_pk_fma_f32 v[148:149], v[50:51], v[94:95], v[148:149]
v_pk_fma_f32 v[146:147], v[52:53], v[96:97], v[146:147]
v_pk_fma_f32 v[148:149], v[56:57], v[96:97], v[148:149]
v_pk_fma_f32 v[146:147], v[54:55], v[98:99], v[146:147]
v_pk_fma_f32 v[148:149], v[58:59], v[98:99], v[148:149]
v_cvt_pk_bf16_f32 v212, v146, v148
v_cvt_pk_bf16_f32 v213, v147, v149
global_store_dword v174, v212, s[40:41]
v_pk_mul_f32 v[122:123], v[68:69], v[92:93]
v_pk_fma_f32 v[122:123], v[70:71], v[94:95], v[122:123]
global_store_dword v174, v213, s[40:41] offset:256
v_pk_fma_f32 v[122:123], v[72:73], v[96:97], v[122:123]
v_pk_fma_f32 v[122:123], v[74:75], v[98:99], v[122:123]
s_mov_b64 exec, s[48:49]
global_store_dwordx4 v175, v[120:123], s[40:41]
s_mov_b64 exec, -1
v_add_u32 v214, 1056, v193
ds_read2_b32 v[100:101], v193 offset0:0 offset1:4
ds_read2_b32 v[102:103], v193 offset0:132 offset1:136
ds_read2_b32 v[104:105], v214 offset0:0 offset1:4
ds_read2_b32 v[106:107], v214 offset0:132 offset1:136
v_mov_b64 v[44:45], 0
v_mov_b64 v[46:47], 0
v_mov_b64 v[48:49], 0
v_mov_b64 v[50:51], 0
v_mov_b64 v[52:53], 0
v_mov_b64 v[54:55], 0
v_mov_b64 v[56:57], 0
v_mov_b64 v[58:59], 0
s_waitcnt lgkmcnt(0)
v_pk_add_f32 v[100:101], v[100:101], v[102:103]
v_pk_add_f32 v[104:105], v[104:105], v[106:107]
v_pk_add_f32 v[100:101], v[100:101], v[104:105]
v_cvt_pk_bf16_f32 v214, v100, v101
v_lshlrev_b32 v158, 16, v214
v_and_b32 v159, 0xffff0000, v214
v_mul_f32 v158, s46, v158
v_mul_f32 v159, s46, v159
s_sleep 2
L_r7_A0:
global_load_dwordx3 v[36:38], v171, s[40:41] sc1
global_load_dwordx4 v[20:23], v170, s[40:41] sc1
global_load_dwordx4 v[24:27], v170, s[40:41] offset:2048 sc1
s_add_u32 s15, s15, 1
s_cmp_lt_u32 s15, 100000
s_cbranch_scc0 L_fail
s_waitcnt vmcnt(2)
v_max_f32_dpp v142, v36, v36 quad_perm:[1,0,3,2] row_mask:0xf bank_mask:0xf
v_max_u32 v218, v36, v38
s_nop 0
v_max_f32_dpp v142, v142, v142 quad_perm:[2,3,0,1] row_mask:0xf bank_mask:0xf
s_nop 1
v_max_f32_dpp v142, v142, v142 row_half_mirror row_mask:0xf bank_mask:0xf
s_nop 1
v_subrev_f32_dpp v212, v142, v36 row_newbcast:0 row_mask:0xf bank_mask:0xf
v_exp_f32 v212, v212
s_waitcnt vmcnt(1)
v_max3_u32 v218, v218, v20, v21
v_max3_u32 v218, v218, v22, v23
v_perm_b32 v213, v212, v212, s56
v_mul_f32 v143, v212, v38
s_nop 0
v_and_b32_dpp v84, v213, v16 row_newbcast:8 row_mask:0xf bank_mask:0xf
v_and_b32_dpp v85, v213, v17 row_newbcast:8 row_mask:0xf bank_mask:0xf
v_and_b32_dpp v86, v213, v18 row_newbcast:8 row_mask:0xf bank_mask:0xf
v_and_b32_dpp v87, v213, v19 row_newbcast:8 row_mask:0xf bank_mask:0xf
v_and_b32_dpp v88, v213, v16 row_newbcast:9 row_mask:0xf bank_mask:0xf
v_and_b32_dpp v89, v213, v17 row_newbcast:9 row_mask:0xf bank_mask:0xf
v_mfma_f32_16x16x32_bf16 v[40:43], v[84:87], v[20:23], 0
v_and_b32_dpp v90, v213, v18 row_newbcast:9 row_mask:0xf bank_mask:0xf
v_and_b32_dpp v91, v213, v19 row_newbcast:9 row_mask:0xf bank_mask:0xf
v_add_f32_dpp v143, v143, v143 quad_perm:[1,0,3,2] row_mask:0xf bank_mask:0xf
s_waitcnt vmcnt(0)
v_mfma_f32_16x16x32_bf16 v[40:43], v[88:91], v[24:27], v[40:43]
v_max3_u32 v218, v218, v24, v25
v_max3_u32 v218, v218, v26, v27
v_add_f32_dpp v143, v143, v143 quad_perm:[2,3,0,1] row_mask:0xf bank_mask:0xf
v_cmp_eq_u32 vcc, -1, v218
s_nop 0
v_add_f32_dpp v143, v143, v143 row_half_mirror row_mask:0xf bank_mask:0xf
s_cbranch_vccnz L_r7_A0
s_mov_b64 exec, 1
ds_write_b64 v200, v[142:143]
s_mov_b64 exec, -1
v_cvt_pk_bf16_f32 v140, v40, v41
v_cvt_pk_bf16_f32 v141, v42, v43
ds_write2_b32 v191, v140, v141 offset0:0 offset1:8
s_waitcnt lgkmcnt(0)
s_barrier
ds_read_b128 v[84:87], v194 offset:4224
ds_read_b128 v[100:103], v201
ds_read_b128 v[104:107], v202
ds_read_b128 v[88:91], v194 offset:5280
s_mov_b64 exec, 3
global_store_dword v181, v223, s[28:29] sc1
s_mov_b64 exec, -1
s_waitcnt lgkmcnt(3)
v_smfmac_f32_16x16x64_bf16 v[44:47], v[84:87], a[128:135], v208
s_waitcnt lgkmcnt(1)
v_max3_f32 v212, v100, v102, v104
v_smfmac_f32_16x16x64_bf16 v[48:51], v[84:87], a[144:151], v208
v_max_f32 v212, v212, v106
v_sub_f32 v92, v100, v212
s_waitcnt lgkmcnt(0)
v_smfmac_f32_16x16x64_bf16 v[44:47], v[88:91], a[136:143], v208
v_sub_f32 v93, v102, v212
v_exp_f32 v92, v92
v_smfmac_f32_16x16x64_bf16 v[48:51], v[88:91], a[152:159], v208
v_sub_f32 v94, v104, v212
v_exp_f32 v93, v93
v_smfmac_f32_16x16x64_bf16 v[52:55], v[84:87], a[160:167], v208
v_sub_f32 v95, v106, v212
v_exp_f32 v94, v94
v_smfmac_f32_16x16x64_bf16 v[56:59], v[84:87], a[176:183], v208
v_mul_f32 v213, v92, v101
v_exp_f32 v95, v95
v_smfmac_f32_16x16x64_bf16 v[52:55], v[88:91], a[168:175], v208
v_fma_f32 v213, v93, v103, v213
v_fma_f32 v213, v94, v105, v213
v_smfmac_f32_16x16x64_bf16 v[56:59], v[88:91], a[184:191], v208
v_fma_f32 v213, v95, v107, v213
v_rcp_f32 v213, v213
v_pk_add_f32 v[146:147], v[44:45], v[46:47]
v_pk_add_f32 v[148:149], v[48:49], v[50:51]
v_mul_f32 v146, v146, v92
v_mul_f32 v148, v148, v92
v_fma_f32 v146, v147, v93, v146
v_fma_f32 v148, v149, v93, v148
v_pk_add_f32 v[150:151], v[52:53], v[54:55]
v_pk_add_f32 v[152:153], v[56:57], v[58:59]
v_permlane16_swap_b32 v146, v148
v_mul_f32 v150, v150, v92
v_mul_f32 v152, v152, v92
v_fma_f32 v150, v151, v93, v150
v_fma_f32 v152, v153, v93, v152
v_add_f32 v146, v146, v148
v_fma_f32 v146, v146, v213, v158
v_permlane16_swap_b32 v150, v152
v_add_f32 v150, v150, v152
v_fma_f32 v150, v150, v213, v159
v_cvt_pk_bf16_f32 v212, v146, v150
global_store_dword v176, v212, s[40:41] sc1
s_endpgm
L_fr_A:
s_sleep 1
s_add_u32 s15, s15, 1
s_cmp_lt_u32 s15, 100000
s_cbranch_scc0 L_fail
global_load_dwordx4 v[128:131], v179, s[28:29] sc1
s_waitcnt vmcnt(0)
s_branch L_fc_A
L_cr_A0:
s_sleep 1
s_add_u32 s15, s15, 1
s_cmp_lt_u32 s15, 100000
s_cbranch_scc0 L_fail
global_load_dwordx4 v[20:23], v168, s[38:39] sc1
global_load_dwordx4 v[24:27], v168, s[38:39] offset:1024 sc1
global_load_dwordx4 v[28:31], v168, s[40:41] sc1
global_load_dwordx4 v[32:35], v168, s[40:41] offset:1024 sc1
s_waitcnt vmcnt(0)
s_branch L_cc_A0
L_endA:
s_endpgm
L_B:
s_getpc_b64 s[58:59]
L_pcB:
v_lshlrev_b32 v212, 6, v0
v_min_u32 v212, L_endB-L_pcB, v212
v_add_co_u32 v160, vcc, s58, v212
v_mov_b32 v212, s59
s_nop 0
v_addc_co_u32 v161, vcc, 0, v212, vcc
global_load_dword v218, v[160:161], off
v_lshrrev_b32 v212, 6, v0
v_mov_b32 v209, v0
v_and_b32 v0, 63, v0
v_and_b32 v210, 15, v0
v_readfirstlane_b32 s30, v212
s_bfe_u32 s31, s2, 0x20001
s_lshr_b32 s32, s2, 3
s_lshr_b32 s33, s2, 5
s_and_b32 s34, s32, 3
s_and_b32 s35, s32, 7
s_lshr_b32 s36, s2, 6
v_lshrrev_b32 v211, 4, v0
v_lshrrev_b32 v217, 5, v0
v_and_b32 v212, 31, v0
v_lshlrev_b32 v216, 4, v212
v_lshlrev_b32 v212, 6, v217
v_xor_b32 v213, v216, v212
s_and_b32 s60, s30, 1
s_lshl_b32 s57, s60, 7
v_xor_b32 v213, s57, v213
s_lshl_b32 s57, s33, 20
s_lshl_b32 s58, s30, 14
s_add_u32 s57, s57, s58
s_lshl_b32 s58, s31, 11
s_add_u32 s57, s57, s58
s_lshl_b32 s58, s34, 9
s_add_u32 s57, s57, s58
v_lshl_add_u32 v183, v217, 13, v213
v_add_u32 v183, s57, v183
s_lshl_b32 s44, s30, 10
s_mul_i32 s45, s30, 8320
s_lshl_b32 s3, s30, 13
s_lshr_b32 s57, s31, 1
s_lshl_b32 s57, s57, 19
s_and_b32 s58, s31, 1
s_lshl_b32 s58, s58, 16
s_add_u32 s57, s57, s58
s_add_u32 s62, s57, 2097152
s_lshl_b32 s57, s31, 3
s_add_u32 s57, s57, s35
s_lshl_b32 s57, s57, 8
s_lshl_b32 s58, s36, 15
s_add_u32 s63, s57, s58
s_lshl_b32 s57, s31, 14
s_add_u32 s64, s57, 1048576
s_lshl_b32 s58, s33, 8
s_lshl_b32 s59, s34, 12
s_add_u32 s59, s59, s58
s_add_u32 s65, s64, s59
s_lshl_b32 s66, s31, 12
s_lshl_b32 s57, s31, 13
s_add_u32 s69, s57, 1146880
s_lshl_b32 s59, s34, 11
s_add_u32 s59, s59, s58
s_add_u32 s67, s69, s59
s_lshl_b32 s57, s32, 7
s_add_u32 s68, s66, s57
v_lshlrev_b32 v215, 4, v210
v_lshl_add_u32 v212, v211, 11, v215
v_add_u32 v178, s65, v212
v_bfe_u32 v212, v0, 3, 1
v_mul_u32_u24 v212, 16256, v212
s_add_u32 s57, s68, 1114112
v_add3_u32 v212, v212, s57, v215
v_cmp_le_u32 vcc, 32, v0
s_nop 1
v_cndmask_b32 v178, v178, v212, vcc
v_add_u32 v212, s67, v215
v_cmp_le_u32 vcc, 48, v0
s_nop 1
v_cndmask_b32 v178, v178, v212, vcc
s_lshl_b32 s57, s30, 15
s_lshl_b32 s58, s32, 9
s_add_u32 s57, s57, s58
s_add_u32 s57, s57, s62
v_lshl_add_u32 v212, v217, 14, v216
v_add_u32 v212, s57, v212
s_movk_i32 s57, 128
s_movk_i32 s58, 192
v_cmp_le_u32 vcc, s57, v209
s_nop 1
v_cndmask_b32 v178, v212, v178, vcc
v_lshl_add_u32 v212, v211, 13, v215
v_add_u32 v212, s63, v212
v_cmp_le_u32 vcc, s58, v209
s_nop 1
v_cndmask_b32 v177, v178, v212, vcc
v_mov_b64 v[116:117], -1
v_mov_b64 v[118:119], -1
v_and_b32 v214, 1, v211
v_lshl_add_u32 v214, v214, 3, v215
s_getreg_b32 s54, hwreg(HW_REG_XCC_ID, 0, 4)
s_bfe_u32 s55, s54, 0x10002
s_lshl_b32 s54, s54, 28
s_waitcnt lgkmcnt(0)
s_add_u32 s28, s28, 0x1fffff
s_addc_u32 s29, s29, 0
s_and_b32 s28, s28, 0xffe00000
s_add_u32 s38, s28, 131072
s_addc_u32 s39, s29, 0
s_add_u32 s40, s28, 393216
s_addc_u32 s41, s29, 0
s_add_u32 s58, s28, 1736704
s_addc_u32 s59, s29, 0
s_load_dword s26, s[58:59], 0
global_store_dwordx4 v177, v[116:119], s[38:39] sc1
global_store_dwordx4 v177, v[116:119], s[40:41] sc1
s_add_u32 m0, s44, 77312
s_nop 0
global_load_lds_dwordx4 v183, s[20:21] nt
s_add_u32 m0, s44, 81416
v_add_u32 v187, 65536, v183
global_load_lds_dwordx4 v187, s[20:21] nt
s_add_u32 m0, s44, 85520
v_add_u32 v187, 131072, v183
global_load_lds_dwordx4 v187, s[20:21] nt
s_add_u32 m0, s44, 89624
v_add_u32 v187, 196608, v183
global_load_lds_dwordx4 v187, s[20:21] nt
s_lshl_b32 s57, s31, 24
s_lshl_b32 s58, s32, 15
s_add_u32 s57, s57, s58
s_add_u32 s57, s57, s3
s_add_u32 s57, s57, 15728640
v_xor_b32 v212, v210, v217
v_lshlrev_b32 v212, 4, v212
v_lshl_add_u32 v184, v211, 8, v212
v_add_u32 v184, s57, v184
v_and_b32 v221, 1, v211
v_lshlrev_b32 v221, 6, v221
v_xor_b32 v212, v215, v221
v_lshl_add_u32 v185, v211, 8, v212
v_add_u32 v185, s57, v185
s_lshl_b32 s57, s31, 21
s_lshl_b32 s58, s35, 18
s_add_u32 s57, s57, s58
s_lshl_b32 s58, s30, 12
s_add_u32 s57, s57, s58
s_lshl_b32 s58, s36, 9
s_add_u32 s57, s57, s58
v_lshl_add_u32 v186, v217, 11, v213
v_add_u32 v186, s57, v186
s_lshl_b32 s57, s2, 2
s_add_u32 s57, s57, s30
s_lshr_b32 s58, s57, 6
s_lshl_b32 s58, s58, 14
s_and_b32 s57, s57, 63
s_lshl_b32 s57, s57, 7
s_add_u32 s57, s57, s58
s_lshl_b32 s58, s60, 13
s_add_u32 s57, s57, s58
s_add_u32 s57, s57, 786432
s_xor_b32 s58, s57, 0x2000
s_add_u32 s82, s28, s57
s_addc_u32 s83, s29, 0
s_add_u32 s90, s28, s58
s_addc_u32 s91, s29, 0
s_mov_b32 s84, 0x5bd1e995
s_not_b32 s85, s84
s_mov_b64 s[88:89], s[84:85]
s_xor_b32 s73, s60, s55
s_lshl_b32 s73, s73, 1
s_sub_u32 s73, s73, 1
s_lshl_b32 s57, s2, 7
s_lshl_b32 s58, s30, 4
s_add_u32 s57, s57, s58
s_add_u32 s57, s57, 1703936
v_mov_b32 v180, s57
v_lshlrev_b32 v212, 4, v0
s_lshl_b32 s61, s30, 11
s_lshl_b32 s57, s33, 14
s_add_u32 s57, s57, s61
s_add_u32 s57, s57, 0
v_add_u32 v166, s57, v212
s_lshl_b32 s57, s30, 12
s_add_u32 s57, s57, s64
v_add_u32 v167, s57, v212
s_add_u32 s57, s61, s69
v_add_u32 v168, s57, v212
s_lshr_b32 s58, s35, 1
s_and_b32 s59, s35, 1
s_lshl_b32 s57, s58, 14
s_add_u32 s57, s57, s62
s_lshl_b32 s70, s59, 8
s_add_u32 s57, s57, s70
s_lshl_b32 s70, s30, 12
s_add_u32 s57, s57, s70
v_lshl_add_u32 v212, v211, 9, v215
v_add_u32 v170, s57, v212
s_lshl_b32 s58, s58, 4
s_lshl_b32 s59, s59, 2
s_add_u32 s57, s58, s59
s_add_u32 s57, s57, s66
s_add_u32 s57, s57, s44
s_add_u32 s57, s57, 1130496
v_and_b32 v216, 1, v0
v_lshl_add_u32 v222, v216, 2, v211
v_and_b32 v220, 7, v0
v_and_b32 v212, 8, v0
v_cmp_ne_u32 vcc, 0, v212
s_nop 1
v_cndmask_b32 v222, v220, v222, vcc
v_lshl_add_u32 v171, v222, 7, s57
s_lshl_b32 s57, s30, 7
s_add_u32 s57, s57, s66
s_add_u32 s57, s57, 1114112
v_bfe_u32 v212, v0, 1, 3
v_lshlrev_b32 v212, 9, v212
v_lshl_add_u32 v212, v216, 4, v212
v_add_u32 v169, s57, v212
s_and_b32 s57, s2, 7
s_lshl_b32 s58, s30, 3
s_add_u32 s57, s57, s58
v_lshl_add_u32 v212, v220, 5, s57
s_lshl_b32 s57, s36, 6
s_lshl_b32 s58, s30, 1
s_add_u32 s57, s57, s58
s_add_u32 s57, s57, 0
v_lshl_add_u32 v222, v220, 3, s57
v_cmp_le_u32 vcc, 32, v0
s_nop 1
v_cndmask_b32 v212, v212, v222, vcc
v_bfe_u32 v222, v0, 3, 2
v_lshlrev_b32 v222, 4, v222
v_lshl_add_u32 v212, v212, 7, v222
v_add_u32 v179, 1703936, v212
s_lshl_b32 s57, s33, 14
s_lshl_b32 s58, s34, 11
s_add_u32 s57, s57, s58
s_add_u32 s59, s57, 524288
v_and_b32 v212, 3, v0
v_lshl_add_u32 v182, v212, 9, s59
s_lshl_b32 s58, s36, 15
s_add_u32 s59, s58, 524288
v_and_b32 v182, 16, v0
v_lshlrev_b32 v182, 10, v182
v_lshl_add_u32 v182, v210, 9, v182
v_add_u32 v182, s59, v182
s_lshl_b32 s58, s31, 9
s_add_u32 s57, s57, s58
s_lshl_b32 s58, s30, 7
s_add_u32 s57, s57, s58
s_add_u32 s57, s57, 655360
v_lshl_add_u32 v181, v216, 13, s57
v_lshl_add_u32 v222, v210, 2, v221
s_lshl_b32 s70, s60, 7
s_lshr_b32 s71, s30, 1
s_lshl_b32 s57, s71, 11
s_add_u32 s57, s57, s65
s_add_u32 s57, s57, s70
v_add_u32 v172, s57, v222
s_lshl_b32 s57, s71, 18
s_add_u32 s57, s57, s67
s_add_u32 s57, s57, s70
v_add_u32 v212, s57, v222
v_cmp_le_u32 vcc, 32, v0
s_nop 1
v_cndmask_b32 v172, v172, v212, vcc
s_lshl_b32 s57, s71, 14
s_add_u32 s57, s57, s63
s_add_u32 s57, s57, s70
v_lshl_add_u32 v212, v217, 13, v222
v_add_u32 v176, s57, v212
s_lshl_b32 s57, s32, 9
s_lshl_b32 s58, s30, 6
s_add_u32 s57, s57, s58
s_add_u32 s57, s57, s62
v_lshlrev_b32 v212, 2, v210
v_lshl_add_u32 v212, v211, 14, v212
v_add_u32 v174, s57, v212
s_lshl_b32 s57, s30, 4
s_add_u32 s58, s57, s68
s_add_u32 s58, s58, 1114112
v_lshl_add_u32 v173, v211, 2, s58
s_add_u32 s58, s68, 1130496
v_lshl_add_u32 v175, v211, 4, s58
s_lshl_b64 s[48:49], 1, s57
s_mov_b32 s50, 0xcccccccc
s_mov_b32 s51, 0xcccccccc
s_mov_b32 s52, 0x10001
s_mov_b32 s53, 0x10001
s_and_b32 s57, s33, 1
s_cmp_eq_u32 s57, s71
s_cselect_b32 s46, 0x3d800000, 0
s_mov_b32 s56, 0x03020302
s_mov_b32 s15, 0
s_mov_b32 s14, 0
v_lshrrev_b32 v212, 1, v211
v_mul_u32_u24 v212, 12, v212
v_and_b32 v188, 1, v211
v_lshl_add_u32 v212, v188, 0, v212
v_xor_b32 v212, v212, v210
v_lshlrev_b32 v212, 4, v212
v_lshl_add_u32 v194, v211, 8, v212
v_lshrrev_b32 v212, 1, v211
v_mul_u32_u24 v212, 12, v212
v_and_b32 v188, 1, v211
v_lshl_add_u32 v212, v188, 1, v212
v_xor_b32 v212, v212, v210
v_lshlrev_b32 v212, 4, v212
v_lshl_add_u32 v196, v211, 8, v212
s_mul_i32 s57, s60, 1056
v_add_u32 v195, s57, v194
v_bfe_u32 v222, v0, 1, 2
v_bfe_u32 v219, v0, 3, 1
v_mul_u32_u24 v219, 1056, v219
v_lshl_add_u32 v219, v222, 8, v219
v_lshl_add_u32 v219, v216, 3, v219
v_lshrrev_b32 v212, 4, v221
v_add_u32 v219, v219, v212
v_lshrrev_b32 v212, 1, v222
v_mul_u32_u24 v212, 12, v212
v_and_b32 v188, 1, v222
v_lshl_add_u32 v212, v188, 0, v212
s_lshl_b32 s57, s71, 2
s_add_u32 s57, s57, s60
v_xor_b32 v222, s57, v212
v_lshl_add_u32 v189, v222, 4, v219
v_lshlrev_b32 v188, 3, v217
v_xor_b32 v222, v222, v188
v_lshl_add_u32 v191, v222, 4, v219
v_add_u32 v191, 4224, v191
s_lshl_b32 s57, s30, 2
v_add_u32 v222, s57, v217
v_xor_b32 v222, v222, v212
v_lshl_add_u32 v190, v222, 4, v219
v_add_u32 v190, 2112, v190
v_and_b32 v216, 3, v210
v_lshrrev_b32 v219, 2, v210
v_lshrrev_b32 v212, 1, v219
v_mul_u32_u24 v212, 12, v212
v_and_b32 v188, 1, v219
v_lshl_add_u32 v212, v188, 1, v212
s_lshl_b32 s57, s60, 1
v_lshl_add_u32 v222, v211, 2, s57
v_xor_b32 v222, v222, v212
v_lshlrev_b32 v222, 4, v222
v_lshl_add_u32 v222, v219, 8, v222
s_mul_i32 s57, s71, 1056
s_add_u32 s57, s57, 6336
v_lshl_add_u32 v222, v216, 2, v222
v_add_u32 v197, s57, v222
v_lshlrev_b32 v199, 5, v211
v_add_u32 v199, 8448, v199
s_lshl_b32 s57, s30, 3
v_add_u32 v198, s57, v199
s_add_u32 s58, s57, 8576
v_mov_b32 v200, s58
s_add_u32 s58, s57, 8608
v_mov_b32 v203, s58
v_lshrrev_b32 v212, 2, v221
v_add_u32 v201, 8576, v212
v_sub_u32 v202, 8592, v212
s_mul_i32 s57, s30, 528
s_add_u32 s57, s57, 8640
v_lshl_add_u32 v192, v214, 1, s57
s_lshl_b32 s57, s60, 8
s_add_u32 s57, s57, 8640
v_lshl_add_u32 v212, v221, 1, s57
v_lshl_add_u32 v212, v219, 5, v212
v_lshl_add_u32 v193, v216, 2, v212
v_mul_u32_u24 v212, 4104, v211
v_lshl_add_u32 v212, v219, 9, v212
v_add_u32 v212, 77312, v212
s_lshl_b32 s57, s30, 3
v_add_u32 v222, s57, v216
v_lshlrev_b32 v188, 2, v219
v_xor_b32 v222, v222, v188
v_lshl_add_u32 v204, v222, 4, v212
v_xor_b32 v222, 4, v222
v_lshl_add_u32 v205, v222, 4, v212
v_mul_u32_u24 v212, 1032, v211
v_lshrrev_b32 v188, 1, v219
v_mul_u32_u24 v188, 8320, v188
v_add_u32 v212, v212, v188
v_and_b32 v215, 1, v219
v_lshl_add_u32 v212, v215, 8, v212
s_lshl_b32 s57, s30, 2
v_add_u32 v222, s57, v216
v_lshlrev_b32 v188, 2, v215
v_xor_b32 v222, v222, v188
v_lshl_add_u32 v212, v222, 4, v212
v_add_u32 v206, 44032, v212
v_xor_b32 v212, v211, v210
v_lshlrev_b32 v212, 4, v212
v_lshl_add_u32 v212, v210, 9, v212
s_add_u32 s57, s3, 11264
v_add_u32 v207, s57, v212
v_lshlrev_b32 v215, 4, v215
v_mov_b32 v213, 0xffff
v_lshlrev_b32 v213, v215, v213
v_cmp_eq_u32 vcc, 0, v216
s_nop 1
v_cndmask_b32 v16, 0, v213, vcc
v_and_b32 v4, 0x3f803f80, v16
v_cmp_eq_u32 vcc, 1, v216
s_nop 1
v_cndmask_b32 v17, 0, v213, vcc
v_and_b32 v5, 0x3f803f80, v17
v_cmp_eq_u32 vcc, 2, v216
s_nop 1
v_cndmask_b32 v18, 0, v213, vcc
v_and_b32 v6, 0x3f803f80, v18
v_cmp_eq_u32 vcc, 3, v216
s_nop 1
v_cndmask_b32 v19, 0, v213, vcc
v_and_b32 v7, 0x3f803f80, v19
v_cmp_gt_u32 vcc, 8, v210
s_nop 1
v_cndmask_b32 v8, 0, v4, vcc
v_sub_u32 v12, v4, v8
v_cndmask_b32 v9, 0, v5, vcc
v_sub_u32 v13, v5, v9
v_cndmask_b32 v10, 0, v6, vcc
v_sub_u32 v14, v6, v10
v_cndmask_b32 v11, 0, v7, vcc
v_sub_u32 v15, v7, v11
v_mov_b32 v132, 0x3f803f80
v_mov_b32 v133, 0x3f803f80
v_mov_b32 v134, 0x3f803f80
v_mov_b32 v135, 0x3f803f80
v_mov_b32 v136, 0x3f803f80
v_mov_b32 v137, 0x3f803f80
v_mov_b32 v138, 0x3f803f80
v_mov_b32 v139, 0x3f803f80
v_mov_b32 v208, 0x44444444
v_mov_b32 v212, 0xeeeeeeee
v_cndmask_b32 v208, v208, v212, s[50:51]
v_and_b32 v212, 13, v210
v_cmp_eq_u32 vcc, 8, v212
s_nop 1
v_cndmask_b32 v76, 0, v132, vcc
v_cndmask_b32 v77, 0, v132, vcc
v_cndmask_b32 v78, 0, v132, vcc
v_cndmask_b32 v79, 0, v132, vcc
ds_write_b128 v194, v[76:79] offset:0
ds_write_b128 v194, v[76:79] offset:1056
s_waitcnt vmcnt(4)
s_waitcnt lgkmcnt(0)
s_mul_i32 s26, s26, 0x9e3779b1
s_add_u32 s26, s26, 0x7f4a7c15
s_xor_b32 s92, s26, s54
v_mov_b32 v162, s92
s_mov_b64 exec, 1
global_store_dword v180, v162, s[28:29] sc1
s_mov_b64 exec, -1
global_load_dword v218, v178, s[38:39] sc1
global_load_dword v218, v178, s[40:41] sc1
s_waitcnt lgkmcnt(0)
s_load_dwordx2 s[86:87], s[82:83], 0
s_load_dwordx2 s[88:89], s[90:91], 0
v_mov_b32 v160, s26
s_waitcnt lgkmcnt(2)
s_cmp_eq_u64 s[88:89], s[84:85]
s_cselect_b32 s73, s73, 0
v_mov_b32 v161, s73
s_mov_b64 exec, 1
global_store_dwordx2 v180, v[160:161], s[28:29] offset:8 sc1
s_mov_b64 exec, -1
s_waitcnt vmcnt(7)
s_add_u32 m0, s44, 93728
v_add_u32 v187, 262144, v183
global_load_lds_dwordx4 v187, s[20:21] nt
s_waitcnt vmcnt(7)
s_add_u32 m0, s44, 97832
v_add_u32 v187, 327680, v183
global_load_lds_dwordx4 v187, s[20:21] nt
s_waitcnt vmcnt(7)
s_add_u32 m0, s44, 101936
v_add_u32 v187, 393216, v183
global_load_lds_dwordx4 v187, s[20:21] nt
s_waitcnt vmcnt(7)
s_add_u32 m0, s44, 106040
v_add_u32 v187, 458752, v183
global_load_lds_dwordx4 v187, s[20:21] nt
s_waitcnt vmcnt(3)
s_add_u32 m0, s44, 110144
v_add_u32 v187, 524288, v183
global_load_lds_dwordx4 v187, s[20:21] nt
s_waitcnt vmcnt(3)
s_add_u32 m0, s44, 114248
v_add_u32 v187, 589824, v183
global_load_lds_dwordx4 v187, s[20:21] nt
s_waitcnt vmcnt(3)
s_add_u32 m0, s44, 118352
v_add_u32 v187, 655360, v183
global_load_lds_dwordx4 v187, s[20:21] nt
s_waitcnt vmcnt(3)
s_add_u32 m0, s44, 122456
v_add_u32 v187, 720896, v183
global_load_lds_dwordx4 v187, s[20:21] nt
s_waitcnt vmcnt(4)
s_waitcnt lgkmcnt(0)
s_barrier
ds_read_b64_tr_b16 a[0:1], v204 offset:0
ds_read_b64_tr_b16 a[2:3], v204 offset:2048
ds_read_b64_tr_b16 a[16:17], v205 offset:0
ds_read_b64_tr_b16 a[18:19], v205 offset:2048
ds_read_b64_tr_b16 a[32:33], v204 offset:8
ds_read_b64_tr_b16 a[34:35], v204 offset:2056
ds_read_b64_tr_b16 a[48:49], v205 offset:8
ds_read_b64_tr_b16 a[50:51], v205 offset:2056
ds_read_b64_tr_b16 a[4:5], v204 offset:16416
ds_read_b64_tr_b16 a[6:7], v204 offset:18464
ds_read_b64_tr_b16 a[20:21], v205 offset:16416
ds_read_b64_tr_b16 a[22:23], v205 offset:18464
ds_read_b64_tr_b16 a[36:37], v204 offset:16424
ds_read_b64_tr_b16 a[38:39], v204 offset:18472
ds_read_b64_tr_b16 a[52:53], v205 offset:16424
ds_read_b64_tr_b16 a[54:55], v205 offset:18472
s_waitcnt vmcnt(3)
s_add_u32 m0, s44, 126560
v_add_u32 v187, 786432, v183
global_load_lds_dwordx4 v187, s[20:21] nt
s_waitcnt vmcnt(3)
s_add_u32 m0, s44, 130664
v_add_u32 v187, 851968, v183
global_load_lds_dwordx4 v187, s[20:21] nt
s_waitcnt vmcnt(3)
s_add_u32 m0, s44, 134768
v_add_u32 v187, 917504, v183
global_load_lds_dwordx4 v187, s[20:21] nt
s_waitcnt vmcnt(3)
s_add_u32 m0, s44, 138872
v_add_u32 v187, 983040, v183
global_load_lds_dwordx4 v187, s[20:21] nt
global_load_dwordx4 v[128:131], v179, s[28:29] sc1
s_waitcnt vmcnt(5)
s_waitcnt lgkmcnt(0)
s_barrier
ds_read_b64_tr_b16 a[8:9], v204 offset:32832
ds_read_b64_tr_b16 a[10:11], v204 offset:34880
ds_read_b64_tr_b16 a[24:25], v205 offset:32832
ds_read_b64_tr_b16 a[26:27], v205 offset:34880
ds_read_b64_tr_b16 a[40:41], v204 offset:32840
ds_read_b64_tr_b16 a[42:43], v204 offset:34888
ds_read_b64_tr_b16 a[56:57], v205 offset:32840
ds_read_b64_tr_b16 a[58:59], v205 offset:34888
s_waitcnt vmcnt(4)
s_add_u32 m0, s3, 11264
s_nop 0
global_load_lds_dwordx4 v184, s[16:17] offset:0 nt
s_waitcnt vmcnt(4)
v_xor_b32 v187, 32, v184
global_load_lds_dwordx4 v187, s[16:17] offset:1024 nt
s_waitcnt vmcnt(4)
v_xor_b32 v187, 64, v184
global_load_lds_dwordx4 v187, s[16:17] offset:2048 nt
s_waitcnt vmcnt(4)
v_xor_b32 v187, 96, v184
global_load_lds_dwordx4 v187, s[16:17] offset:3072 nt
s_waitcnt vmcnt(5)
s_waitcnt lgkmcnt(0)
s_barrier
ds_read_b64_tr_b16 a[12:13], v204 offset:49248
ds_read_b64_tr_b16 a[14:15], v204 offset:51296
ds_read_b64_tr_b16 a[28:29], v205 offset:49248
ds_read_b64_tr_b16 a[30:31], v205 offset:51296
ds_read_b64_tr_b16 a[44:45], v204 offset:49256
ds_read_b64_tr_b16 a[46:47], v204 offset:51304
ds_read_b64_tr_b16 a[60:61], v205 offset:49256
ds_read_b64_tr_b16 a[62:63], v205 offset:51304
s_waitcnt vmcnt(3)
s_add_u32 m0, s3, 15360
v_xor_b32 v187, 128, v184
v_add_u32 v187, 4096, v187
global_load_lds_dwordx4 v187, s[16:17] offset:0 nt
s_waitcnt vmcnt(5)
L_fc_B:
v_xor_b32 v212, s26, v128
v_and_b32 v213, 0xfffffff, v212
s_mov_b32 exec_hi, 0
v_cmp_ne_u32 vcc, 0, v213
s_mov_b32 exec_hi, -1
s_cbranch_vccnz L_fr_B
v_cmp_ne_u32 s[60:61], s54, v212
v_cmp_eq_u32 vcc, s26, v130
s_nop 1
v_cndmask_b32 v213, 0, v131, vcc
v_cmp_lt_i32 s[58:59], 0, v213
v_cmp_gt_i32 vcc, 0, v213
v_mov_b32 v160, s60
s_nop 1
s_bcnt1_i32_b64 s58, s[58:59]
s_bcnt1_i32_b64 s59, vcc
s_sub_u32 s58, s58, s59
v_mov_b32 v161, s58
ds_write_b64 v203, v[160:161]
s_waitcnt lgkmcnt(0)
s_barrier
v_mov_b32 v214, 8608
ds_read_b128 v[100:103], v214
ds_read_b128 v[104:107], v214 offset:16
s_waitcnt lgkmcnt(0)
v_or3_b32 v214, v100, v102, v104
v_add3_u32 v215, v101, v103, v105
v_or_b32 v214, v214, v106
v_add_u32 v215, v215, v107
v_readfirstlane_b32 s37, v214
v_readfirstlane_b32 s72, v215
s_cmp_gt_i32 s72, 0
s_cselect_b32 s57, 1, 0
s_xor_b32 s57, s57, s55
s_lshl_b32 s57, s57, 13
s_add_u32 s42, s28, s57
s_addc_u32 s43, s29, 0
s_cmp_lg_u32 s37, 0
s_cbranch_scc1 L_post_B1
L_post_B0:
s_add_u32 m0, s3, 15360
v_xor_b32 v187, 160, v184
v_add_u32 v187, 4096, v187
global_load_lds_dwordx4 v187, s[16:17] offset:1024 nt
v_mov_b64 v[44:45], 0
v_mov_b64 v[46:47], 0
v_mov_b64 v[48:49], 0
v_mov_b64 v[50:51], 0
v_mov_b64 v[52:53], 0
v_mov_b64 v[54:55], 0
v_mov_b64 v[56:57], 0
v_mov_b64 v[58:59], 0
ds_read_b128 v[84:87], v194 offset:0
ds_read_b128 v[88:91], v194 offset:1056
s_waitcnt lgkmcnt(0)
v_smfmac_f32_16x16x64_bf16 v[44:47], v[84:87], a[0:7], v208
v_smfmac_f32_16x16x64_bf16 v[48:51], v[84:87], a[16:23], v208
s_waitcnt lgkmcnt(0)
v_smfmac_f32_16x16x64_bf16 v[44:47], v[88:91], a[8:15], v208
v_smfmac_f32_16x16x64_bf16 v[48:51], v[88:91], a[24:31], v208
v_smfmac_f32_16x16x64_bf16 v[52:55], v[84:87], a[32:39], v208
v_smfmac_f32_16x16x64_bf16 v[56:59], v[84:87], a[48:55], v208
v_smfmac_f32_16x16x64_bf16 v[52:55], v[88:91], a[40:47], v208
v_smfmac_f32_16x16x64_bf16 v[56:59], v[88:91], a[56:63], v208
s_nop 2
v_pk_add_f32 v[146:147], v[44:45], v[46:47]
v_add_f32 v146, v146, v147
v_pk_add_f32 v[148:149], v[48:49], v[50:51]
v_add_f32 v148, v148, v149
v_pk_add_f32 v[150:151], v[52:53], v[54:55]
v_add_f32 v150, v150, v151
v_pk_add_f32 v[152:153], v[56:57], v[58:59]
v_add_f32 v152, v152, v153
v_permlane16_swap_b32 v146, v148
v_add_f32 v146, v146, v148
v_permlane16_swap_b32 v150, v152
v_add_f32 v150, v150, v152
v_cvt_pk_bf16_f32 v212, v146, v150
s_mov_b32 exec_lo, 0
global_store_dword v172, v212, s[38:39]
s_mov_b32 exec_lo, -1
s_waitcnt vmcnt(5)
v_xor_b32 v187, 192, v184
v_add_u32 v187, 4096, v187
global_load_lds_dwordx4 v187, s[16:17] offset:2048 nt
s_waitcnt vmcnt(5)
v_xor_b32 v187, 224, v184
v_add_u32 v187, 4096, v187
global_load_lds_dwordx4 v187, s[16:17] offset:3072 nt
s_waitcnt vmcnt(5)
s_add_u32 m0, s45, 44032
s_nop 0
global_load_lds_dwordx4 v185, s[18:19] offset:0 nt
s_waitcnt vmcnt(5)
s_add_u32 m0, s45, 44040
s_nop 0
global_load_lds_dwordx4 v185, s[18:19] offset:1024 nt
s_waitcnt vmcnt(5)
s_add_u32 m0, s45, 44048
s_nop 0
global_load_lds_dwordx4 v185, s[18:19] offset:2048 nt
s_waitcnt vmcnt(4)
s_add_u32 m0, s45, 44056
s_nop 0
global_load_lds_dwordx4 v185, s[18:19] offset:3072 nt
s_waitcnt vmcnt(4)
s_add_u32 m0, s45, 48160
v_add_u32 v187, 4096, v185
global_load_lds_dwordx4 v187, s[18:19] offset:0 nt
s_waitcnt vmcnt(5)
v_xor_b32 v187, 0, v207
ds_read_b128 a[64:67], v187 offset:0
ds_read_b128 a[80:83], v187 offset:256
v_xor_b32 v187, 64, v207
ds_read_b128 a[68:71], v187 offset:0
ds_read_b128 a[84:87], v187 offset:256
v_xor_b32 v187, 128, v207
ds_read_b128 a[72:75], v187 offset:0
ds_read_b128 a[88:91], v187 offset:256
v_xor_b32 v187, 192, v207
ds_read_b128 a[76:79], v187 offset:0
ds_read_b128 a[92:95], v187 offset:256
s_waitcnt vmcnt(10)
s_add_u32 m0, s45, 48168
v_add_u32 v187, 4096, v185
global_load_lds_dwordx4 v187, s[18:19] offset:1024 nt
s_waitcnt vmcnt(10)
s_add_u32 m0, s45, 48176
v_add_u32 v187, 4096, v185
global_load_lds_dwordx4 v187, s[18:19] offset:2048 nt
s_waitcnt vmcnt(10)
s_add_u32 m0, s45, 48184
v_add_u32 v187, 4096, v185
global_load_lds_dwordx4 v187, s[18:19] offset:3072 nt
s_waitcnt vmcnt(9)
s_add_u32 m0, s44, 77312
s_nop 0
global_load_lds_dwordx4 v186, s[22:23] nt
s_waitcnt vmcnt(9)
s_add_u32 m0, s44, 81416
v_add_u32 v187, 16384, v186
global_load_lds_dwordx4 v187, s[22:23] nt
s_waitcnt vmcnt(9)
s_add_u32 m0, s44, 85520
v_add_u32 v187, 32768, v186
global_load_lds_dwordx4 v187, s[22:23] nt
s_waitcnt vmcnt(9)
s_add_u32 m0, s44, 89624
v_add_u32 v187, 49152, v186
global_load_lds_dwordx4 v187, s[22:23] nt
s_waitcnt vmcnt(9)
s_add_u32 m0, s44, 93728
v_add_u32 v187, 65536, v186
global_load_lds_dwordx4 v187, s[22:23] nt
s_waitcnt vmcnt(9)
s_add_u32 m0, s44, 97832
v_add_u32 v187, 81920, v186
global_load_lds_dwordx4 v187, s[22:23] nt
s_waitcnt vmcnt(9)
s_add_u32 m0, s44, 101936
v_add_u32 v187, 98304, v186
global_load_lds_dwordx4 v187, s[22:23] nt
s_waitcnt vmcnt(9)
s_add_u32 m0, s44, 106040
v_add_u32 v187, 114688, v186
global_load_lds_dwordx4 v187, s[22:23] nt
s_waitcnt vmcnt(9)
s_add_u32 m0, s44, 110144
v_add_u32 v187, 131072, v186
global_load_lds_dwordx4 v187, s[22:23] nt
s_waitcnt vmcnt(9)
s_add_u32 m0, s44, 114248
v_add_u32 v187, 147456, v186
global_load_lds_dwordx4 v187, s[22:23] nt
s_waitcnt vmcnt(10)
s_waitcnt lgkmcnt(0)
s_barrier
ds_read_b64_tr_b16 a[96:97], v206 offset:0
ds_read_b64_tr_b16 a[98:99], v206 offset:512
ds_read_b64_tr_b16 a[100:101], v206 offset:4128
ds_read_b64_tr_b16 a[102:103], v206 offset:4640
ds_read_b64_tr_b16 a[112:113], v206 offset:8
ds_read_b64_tr_b16 a[114:115], v206 offset:520
ds_read_b64_tr_b16 a[116:117], v206 offset:4136
ds_read_b64_tr_b16 a[118:119], v206 offset:4648
ds_read_b64_tr_b16 a[104:105], v206 offset:16640
ds_read_b64_tr_b16 a[106:107], v206 offset:17152
ds_read_b64_tr_b16 a[108:109], v206 offset:20768
ds_read_b64_tr_b16 a[110:111], v206 offset:21280
ds_read_b64_tr_b16 a[120:121], v206 offset:16648
ds_read_b64_tr_b16 a[122:123], v206 offset:17160
ds_read_b64_tr_b16 a[124:125], v206 offset:20776
ds_read_b64_tr_b16 a[126:127], v206 offset:21288
global_load_dwordx4 v[20:23], v168, s[38:39] sc1
global_load_dwordx4 v[24:27], v168, s[38:39] offset:1024 sc1
global_load_dwordx4 v[28:31], v168, s[40:41] sc1
global_load_dwordx4 v[32:35], v168, s[40:41] offset:1024 sc1
s_waitcnt vmcnt(13)
s_add_u32 m0, s44, 118352
v_add_u32 v187, 163840, v186
global_load_lds_dwordx4 v187, s[22:23] nt
s_waitcnt vmcnt(13)
s_add_u32 m0, s44, 122456
v_add_u32 v187, 180224, v186
global_load_lds_dwordx4 v187, s[22:23] nt
s_waitcnt vmcnt(13)
s_add_u32 m0, s44, 126560
v_add_u32 v187, 196608, v186
global_load_lds_dwordx4 v187, s[22:23] nt
s_waitcnt vmcnt(13)
s_add_u32 m0, s44, 130664
v_add_u32 v187, 212992, v186
global_load_lds_dwordx4 v187, s[22:23] nt
s_waitcnt vmcnt(13)
s_add_u32 m0, s44, 134768
v_add_u32 v187, 229376, v186
global_load_lds_dwordx4 v187, s[22:23] nt
s_waitcnt vmcnt(13)
s_add_u32 m0, s44, 138872
v_add_u32 v187, 245760, v186
global_load_lds_dwordx4 v187, s[22:23] nt
s_waitcnt vmcnt(12)
s_waitcnt lgkmcnt(0)
s_barrier
ds_read_b64_tr_b16 a[128:129], v204 offset:0
ds_read_b64_tr_b16 a[130:131], v204 offset:2048
ds_read_b64_tr_b16 a[144:145], v205 offset:0
ds_read_b64_tr_b16 a[146:147], v205 offset:2048
ds_read_b64_tr_b16 a[160:161], v204 offset:8
ds_read_b64_tr_b16 a[162:163], v204 offset:2056
ds_read_b64_tr_b16 a[176:177], v205 offset:8
ds_read_b64_tr_b16 a[178:179], v205 offset:2056
ds_read_b64_tr_b16 a[132:133], v204 offset:16416
ds_read_b64_tr_b16 a[134:135], v204 offset:18464
ds_read_b64_tr_b16 a[148:149], v205 offset:16416
ds_read_b64_tr_b16 a[150:151], v205 offset:18464
ds_read_b64_tr_b16 a[164:165], v204 offset:16424
ds_read_b64_tr_b16 a[166:167], v204 offset:18472
ds_read_b64_tr_b16 a[180:181], v205 offset:16424
ds_read_b64_tr_b16 a[182:183], v205 offset:18472
v_mov_b64 v[60:61], 0
v_mov_b64 v[62:63], 0
v_mov_b64 v[64:65], 0
v_mov_b64 v[66:67], 0
L_cc_B0:
s_waitcnt vmcnt(9)
v_mfma_f32_16x16x32_bf16 v[40:43], v[8:11], v[20:23], 0
v_max3_u32 v218, v20, v21, v22
v_max_u32 v218, v218, v23
s_waitcnt vmcnt(8)
v_mfma_f32_16x16x32_bf16 v[40:43], v[8:11], v[24:27], v[40:43]
v_max3_u32 v218, v218, v24, v25
v_max3_u32 v218, v218, v26, v27
s_waitcnt vmcnt(7)
v_mfma_f32_16x16x32_bf16 v[40:43], v[12:15], v[28:31], v[40:43]
v_max3_u32 v218, v218, v28, v29
v_max3_u32 v218, v218, v30, v31
s_waitcnt vmcnt(6)
v_mfma_f32_16x16x32_bf16 v[40:43], v[12:15], v[32:35], v[40:43]
v_max3_u32 v218, v218, v32, v33
v_max3_u32 v218, v218, v34, v35
v_cmp_eq_u32 vcc, -1, v218
s_cbranch_vccnz L_cr_B0
s_nop 3
v_cvt_pk_bf16_f32 v140, v40, v41
v_cvt_pk_bf16_f32 v141, v42, v43
ds_write2_b32 v190, v140, v141 offset0:0 offset1:8
s_waitcnt lgkmcnt(0)
s_barrier
ds_read_b128 v[84:87], v194 offset:2112
ds_read_b128 v[88:91], v194 offset:3168
s_waitcnt lgkmcnt(0)
v_smfmac_f32_16x16x64_bf16 v[60:63], v[84:87], a[64:71], v208
v_smfmac_f32_16x16x64_bf16 v[64:67], v[84:87], a[80:87], v208
v_smfmac_f32_16x16x64_bf16 v[60:63], v[88:91], a[72:79], v208
v_smfmac_f32_16x16x64_bf16 v[64:67], v[88:91], a[88:95], v208
s_nop 6
v_pk_add_f32 v[154:155], v[60:61], v[62:63]
v_pk_add_f32 v[156:157], v[64:65], v[66:67]
s_waitcnt vmcnt(4)
s_waitcnt lgkmcnt(0)
s_barrier
ds_read_b64_tr_b16 a[136:137], v204 offset:32832
ds_read_b64_tr_b16 a[138:139], v204 offset:34880
ds_read_b64_tr_b16 a[152:153], v205 offset:32832
ds_read_b64_tr_b16 a[154:155], v205 offset:34880
ds_read_b64_tr_b16 a[168:169], v204 offset:32840
ds_read_b64_tr_b16 a[170:171], v204 offset:34888
ds_read_b64_tr_b16 a[184:185], v205 offset:32840
ds_read_b64_tr_b16 a[186:187], v205 offset:34888
s_waitcnt vmcnt(0)
s_waitcnt lgkmcnt(0)
s_barrier
ds_read_b64_tr_b16 a[140:141], v204 offset:49248
ds_read_b64_tr_b16 a[142:143], v204 offset:51296
ds_read_b64_tr_b16 a[156:157], v205 offset:49248
ds_read_b64_tr_b16 a[158:159], v205 offset:51296
ds_read_b64_tr_b16 a[172:173], v204 offset:49256
ds_read_b64_tr_b16 a[174:175], v204 offset:51304
ds_read_b64_tr_b16 a[188:189], v205 offset:49256
ds_read_b64_tr_b16 a[190:191], v205 offset:51304
s_branch L_al_B0
.p2align 6
s_nop 0
s_nop 0
s_nop 0
L_al_B0:
s_mov_b32 s72, -1
s_mov_b32 s73, 0
s_mov_b64 s[70:71], 3
L_lp_B0:
s_add_u32 s47, s26, 1
s_cmp_eq_u32 s30, 0
s_cbranch_scc0 L_db1_B0
s_mov_b64 exec, s[72:73]
global_load_dword v219, v182, s[42:43] offset:0 sc1
s_sleep 1
global_load_dword v220, v182, s[42:43] offset:128 sc1
s_sleep 1
global_load_dword v221, v182, s[42:43] offset:256 sc1
s_sleep 1
global_load_dword v222, v182, s[42:43] offset:384 sc1
s_sleep 1
L_dp1_B0:
s_waitcnt vmcnt(3)
v_cmp_ne_u32 vcc, s47, v219
s_cbranch_vccz L_dd1_B0
global_load_dword v219, v182, s[42:43] offset:0 sc1
s_sleep 1
s_waitcnt vmcnt(3)
v_cmp_ne_u32 vcc, s47, v220
s_cbranch_vccz L_dd1_B0
global_load_dword v220, v182, s[42:43] offset:128 sc1
s_sleep 1
s_waitcnt vmcnt(3)
v_cmp_ne_u32 vcc, s47, v221
s_cbranch_vccz L_dd1_B0
global_load_dword v221, v182, s[42:43] offset:256 sc1
s_sleep 1
s_waitcnt vmcnt(3)
v_cmp_ne_u32 vcc, s47, v222
s_cbranch_vccz L_dd1_B0
global_load_dword v222, v182, s[42:43] offset:384 sc1
s_sleep 1
s_add_u32 s15, s15, 1
s_cmp_lt_u32 s15, 100000
s_cbranch_scc1 L_dp1_B0
s_branch L_fail
L_dd1_B0:
s_mov_b64 exec, -1
L_db1_B0:
s_barrier
L_r2_B0:
global_load_dwordx4 v[20:23], v166, s[42:43] sc1
global_load_dwordx4 v[24:27], v166, s[42:43] offset:1024 sc1
s_add_u32 s15, s15, 1
s_cmp_lt_u32 s15, 100000
s_cbranch_scc0 L_fail
v_mov_b64 v[44:45], 0
v_mov_b64 v[46:47], 0
v_mov_b64 v[48:49], 0
v_mov_b64 v[50:51], 0
v_mov_b64 v[52:53], 0
v_mov_b64 v[54:55], 0
v_mov_b64 v[56:57], 0
v_mov_b64 v[58:59], 0
s_waitcnt vmcnt(1)
v_mfma_f32_16x16x32_bf16 v[40:43], v[4:7], v[20:23], 0
v_max3_u32 v218, v20, v21, v22
v_max_u32 v218, v218, v23
s_waitcnt vmcnt(0)
v_mfma_f32_16x16x32_bf16 v[40:43], v[4:7], v[24:27], v[40:43]
v_max3_u32 v218, v218, v24, v25
v_max3_u32 v218, v218, v26, v27
v_cmp_eq_u32 vcc, -1, v218
s_cbranch_vccnz L_r2_B0
s_nop 3
v_cvt_pk_bf16_f32 v140, v40, v41
v_cvt_pk_bf16_f32 v141, v42, v43
ds_write2_b32 v189, v140, v141 offset0:0 offset1:8
s_waitcnt lgkmcnt(0)
s_barrier
ds_read_b128 v[80:83], v195 offset:0
ds_read_b128 v[84:87], v194 offset:0
ds_read_b128 v[88:91], v194 offset:1056
s_waitcnt lgkmcnt(2)
v_mfma_f32_16x16x32_bf16 v[76:79], v[80:83], v[80:83], 0
s_waitcnt lgkmcnt(1)
v_smfmac_f32_16x16x64_bf16 v[44:47], v[84:87], a[0:7], v208
v_smfmac_f32_16x16x64_bf16 v[48:51], v[84:87], a[16:23], v208
s_waitcnt lgkmcnt(0)
v_smfmac_f32_16x16x64_bf16 v[44:47], v[88:91], a[8:15], v208
s_nop 2
v_add_f32 v142, v76, v77
v_add_f32 v143, v78, v79
v_smfmac_f32_16x16x64_bf16 v[48:51], v[88:91], a[24:31], v208
v_cndmask_b32 v142, v142, v143, s[50:51]
v_smfmac_f32_16x16x64_bf16 v[52:55], v[84:87], a[32:39], v208
v_add_f32 v146, v44, v46
v_add_f32_dpp v142, v142, v142 quad_perm:[1,0,3,2] row_mask:0xf bank_mask:0xf
v_smfmac_f32_16x16x64_bf16 v[56:59], v[84:87], a[48:55], v208
v_add_f32 v147, v45, v47
v_add_f32_dpp v142, v142, v142 quad_perm:[2,3,0,1] row_mask:0xf bank_mask:0xf
v_smfmac_f32_16x16x64_bf16 v[52:55], v[88:91], a[40:47], v208
v_add_f32 v146, v146, v147
v_add_f32_dpp v142, v142, v142 row_half_mirror row_mask:0xf bank_mask:0xf
v_smfmac_f32_16x16x64_bf16 v[56:59], v[88:91], a[56:63], v208
v_add_f32 v148, v48, v50
v_add_f32 v149, v49, v51
v_add_f32 v148, v148, v149
s_mov_b64 exec, s[52:53]
global_store_dword v173, v142, s[38:39]
s_mov_b64 exec, -1
v_pk_add_f32 v[150:151], v[52:53], v[54:55]
v_permlane16_swap_b32 v146, v148
v_pk_add_f32 v[152:153], v[56:57], v[58:59]
v_add_f32 v150, v150, v151
v_add_f32 v152, v152, v153
v_add_f32 v146, v146, v148
s_mov_b32 exec_hi, 0
v_permlane16_swap_b32 v150, v152
v_add_f32 v150, v150, v152
v_cvt_pk_bf16_f32 v212, v146, v150
global_store_dword v172, v212, s[38:39]
s_mov_b32 exec_hi, -1
ds_write_b128 v192, v[40:43]
s_add_u32 s57, s26, 2
v_mov_b32 v223, s57
s_sleep 3
L_r3_B0:
global_load_dwordx4 v[20:23], v167, s[38:39] sc1
global_load_dwordx4 v[24:27], v167, s[38:39] offset:1024 sc1
global_load_dwordx4 v[28:31], v167, s[38:39] offset:2048 sc1
global_load_dwordx4 v[32:35], v167, s[38:39] offset:3072 sc1
global_load_dwordx4 v[36:39], v169, s[38:39] sc1
s_add_u32 s15, s15, 1
s_cmp_lt_u32 s15, 100000
s_cbranch_scc0 L_fail
v_mov_b64 v[44:45], 0
v_mov_b64 v[46:47], 0
v_mov_b64 v[48:49], 0
v_mov_b64 v[50:51], 0
v_mov_b64 v[52:53], 0
v_mov_b64 v[54:55], 0
v_mov_b64 v[56:57], 0
v_mov_b64 v[58:59], 0
v_mov_b64 v[68:69], 0
v_mov_b64 v[70:71], 0
v_mov_b64 v[72:73], 0
v_mov_b64 v[74:75], 0
v_mov_b64 v[62:63], 0
v_mov_b64 v[66:67], 0
s_waitcnt vmcnt(4)
v_mfma_f32_16x16x32_bf16 v[40:43], v[8:11], v[20:23], 0
v_max3_u32 v218, v20, v21, v22
v_max_u32 v218, v218, v23
s_waitcnt vmcnt(3)
v_mfma_f32_16x16x32_bf16 v[40:43], v[8:11], v[24:27], v[40:43]
v_max3_u32 v218, v218, v24, v25
v_max3_u32 v218, v218, v26, v27
s_waitcnt vmcnt(2)
v_mfma_f32_16x16x32_bf16 v[40:43], v[12:15], v[28:31], v[40:43]
v_max3_u32 v218, v218, v28, v29
v_max3_u32 v218, v218, v30, v31
s_waitcnt vmcnt(1)
v_mfma_f32_16x16x32_bf16 v[40:43], v[12:15], v[32:35], v[40:43]
v_max3_u32 v218, v218, v32, v33
v_max3_u32 v218, v218, v34, v35
s_waitcnt vmcnt(0)
v_max3_u32 v218, v218, v36, v37
v_max_u32 v218, v218, v38
v_cmp_eq_u32 vcc, -1, v218
s_cbranch_vccnz L_r3_B0
s_nop 0
v_cvt_pk_bf16_f32 v140, v40, v41
v_cvt_pk_bf16_f32 v141, v42, v43
ds_write2_b32 v190, v140, v141 offset0:0 offset1:8
v_add_f32 v142, v36, v37
v_add_f32_dpp v143, v38, v38 row_ror:1 row_mask:0xf bank_mask:0xf
s_nop 0
v_add_f32_dpp v142, v142, v142 row_ror:1 row_mask:0xf bank_mask:0xf
v_add_f32_dpp v143, v143, v143 row_ror:2 row_mask:0xf bank_mask:0xf
s_waitcnt lgkmcnt(0)
s_barrier
ds_read_b128 v[84:87], v194 offset:2112
ds_read_b128 v[88:91], v194 offset:3168
v_add_f32_dpp v142, v142, v142 row_ror:2 row_mask:0xf bank_mask:0xf
v_add_f32_dpp v143, v143, v143 row_ror:4 row_mask:0xf bank_mask:0xf
s_nop 0
v_add_f32_dpp v142, v142, v142 row_ror:4 row_mask:0xf bank_mask:0xf
v_add_f32_dpp v143, v143, v143 row_ror:8 row_mask:0xf bank_mask:0xf
s_nop 0
v_add_f32_dpp v142, v142, v142 row_ror:8 row_mask:0xf bank_mask:0xf
v_mul_f32 v145, 0xba800000, v143
v_pk_mul_f32 v[60:61], v[154:155], v[144:145] op_sel:[0,1] op_sel_hi:[1,1]
v_pk_mul_f32 v[64:65], v[156:157], v[144:145] op_sel:[0,1] op_sel_hi:[1,1]
s_waitcnt lgkmcnt(1)
v_smfmac_f32_16x16x64_bf16 v[60:63], v[84:87], a[64:71], v208
v_mul_f32 v212, v145, v145
v_mul_f32 v213, 0x3a800000, v142
v_smfmac_f32_16x16x64_bf16 v[64:67], v[84:87], a[80:87], v208
v_sub_f32 v213, v213, v212
v_max_f32 v213, 0, v213
s_waitcnt lgkmcnt(0)
v_smfmac_f32_16x16x64_bf16 v[60:63], v[88:91], a[72:79], v208
v_add_f32 v213, 0x3727c5ac, v213
v_rsq_f32 v213, v213
v_smfmac_f32_16x16x64_bf16 v[64:67], v[88:91], a[88:95], v208
v_mul_f32 v144, 0x3e0293ee, v213
s_nop 3
v_pk_add_f32 v[146:147], v[60:61], v[62:63]
s_nop 1
v_pk_add_f32 v[148:149], v[64:65], v[66:67]
v_max_f32 v164, v146, v148
v_max_f32 v165, v147, v149
s_nop 0
v_max_f32_dpp v164, v164, v164 row_ror:1 row_mask:0xf bank_mask:0xf
v_max_f32_dpp v165, v165, v165 row_ror:1 row_mask:0xf bank_mask:0xf
s_nop 0
v_max_f32_dpp v164, v164, v164 row_ror:2 row_mask:0xf bank_mask:0xf
v_max_f32_dpp v165, v165, v165 row_ror:2 row_mask:0xf bank_mask:0xf
s_nop 0
v_max_f32_dpp v164, v164, v164 row_ror:4 row_mask:0xf bank_mask:0xf
v_max_f32_dpp v165, v165, v165 row_ror:4 row_mask:0xf bank_mask:0xf
s_nop 0
v_max_f32_dpp v164, v164, v164 row_ror:8 row_mask:0xf bank_mask:0xf
v_max_f32_dpp v165, v165, v165 row_ror:8 row_mask:0xf bank_mask:0xf
v_pk_mul_f32 v[164:165], v[164:165], v[144:145] op_sel_hi:[1,0]
v_ceil_f32 v164, v164
v_ceil_f32 v165, v165
v_pk_fma_f32 v[146:147], v[146:147], v[144:145], v[164:165] op_sel_hi:[1,0,1] neg_lo:[0,0,1] neg_hi:[0,0,1]
v_pk_fma_f32 v[148:149], v[148:149], v[144:145], v[164:165] op_sel_hi:[1,0,1] neg_lo:[0,0,1] neg_hi:[0,0,1]
v_exp_f32 v146, v146
v_exp_f32 v148, v148
v_exp_f32 v147, v147
v_exp_f32 v149, v149
v_cvt_pk_bf16_f32 v212, v146, v148
ds_write_b64 v198, v[164:165]
v_cvt_pk_bf16_f32 v213, v147, v149
ds_write2_b32 v197, v212, v213 offset0:0 offset1:4
s_waitcnt lgkmcnt(0)
s_barrier
ds_read_b128 v[84:87], v196 offset:6336
ds_read_b128 v[92:95], v199
ds_read_b128 v[96:99], v199 offset:16
ds_read_b128 v[88:91], v196 offset:7392
s_waitcnt lgkmcnt(3)
v_smfmac_f32_16x16x64_bf16 v[44:47], v[84:87], a[96:103], v208
s_waitcnt lgkmcnt(1)
v_max3_f32 v120, v92, v94, v96
v_max3_f32 v121, v93, v95, v97
v_smfmac_f32_16x16x64_bf16 v[48:51], v[84:87], a[112:119], v208
v_max_f32 v120, v120, v98
v_max_f32 v121, v121, v99
s_waitcnt lgkmcnt(0)
v_smfmac_f32_16x16x64_bf16 v[52:55], v[88:91], a[104:111], v208
v_sub_f32 v92, v92, v120
v_sub_f32 v93, v93, v121
v_smfmac_f32_16x16x64_bf16 v[56:59], v[88:91], a[120:127], v208
v_sub_f32 v94, v94, v120
v_sub_f32 v95, v95, v121
v_smfmac_f32_16x16x64_bf16 v[68:71], v[84:87], v[132:139], v208
v_sub_f32 v96, v96, v120
v_sub_f32 v97, v97, v121
v_smfmac_f32_16x16x64_bf16 v[72:75], v[88:91], v[132:139], v208
v_sub_f32 v98, v98, v120
v_sub_f32 v99, v99, v121
v_exp_f32 v92, v92
v_exp_f32 v93, v93
v_exp_f32 v94, v94
v_exp_f32 v95, v95
v_exp_f32 v96, v96
v_exp_f32 v97, v97
v_exp_f32 v98, v98
v_exp_f32 v99, v99
v_pk_mul_f32 v[146:147], v[44:45], v[92:93]
v_pk_mul_f32 v[148:149], v[48:49], v[92:93]
v_pk_fma_f32 v[146:147], v[46:47], v[94:95], v[146:147]
v_pk_fma_f32 v[148:149], v[50:51], v[94:95], v[148:149]
v_pk_fma_f32 v[146:147], v[52:53], v[96:97], v[146:147]
v_pk_fma_f32 v[148:149], v[56:57], v[96:97], v[148:149]
v_pk_fma_f32 v[146:147], v[54:55], v[98:99], v[146:147]
v_pk_fma_f32 v[148:149], v[58:59], v[98:99], v[148:149]
v_cvt_pk_bf16_f32 v212, v146, v148
v_cvt_pk_bf16_f32 v213, v147, v149
global_store_dword v174, v212, s[38:39]
v_pk_mul_f32 v[122:123], v[68:69], v[92:93]
v_pk_fma_f32 v[122:123], v[70:71], v[94:95], v[122:123]
global_store_dword v174, v213, s[38:39] offset:256
v_pk_fma_f32 v[122:123], v[72:73], v[96:97], v[122:123]
v_pk_fma_f32 v[122:123], v[74:75], v[98:99], v[122:123]
s_mov_b64 exec, s[48:49]
global_store_dwordx4 v175, v[120:123], s[38:39]
s_mov_b64 exec, -1
v_add_u32 v214, 1056, v193
ds_read2_b32 v[100:101], v193 offset0:0 offset1:4
ds_read2_b32 v[102:103], v193 offset0:132 offset1:136
ds_read2_b32 v[104:105], v214 offset0:0 offset1:4
ds_read2_b32 v[106:107], v214 offset0:132 offset1:136
v_mov_b64 v[44:45], 0
v_mov_b64 v[46:47], 0
v_mov_b64 v[48:49], 0
v_mov_b64 v[50:51], 0
v_mov_b64 v[52:53], 0
v_mov_b64 v[54:55], 0
v_mov_b64 v[56:57], 0
v_mov_b64 v[58:59], 0
s_waitcnt lgkmcnt(0)
v_pk_add_f32 v[100:101], v[100:101], v[102:103]
v_pk_add_f32 v[104:105], v[104:105], v[106:107]
v_pk_add_f32 v[100:101], v[100:101], v[104:105]
v_cvt_pk_bf16_f32 v214, v100, v101
v_lshlrev_b32 v158, 16, v214
v_and_b32 v159, 0xffff0000, v214
v_mul_f32 v158, s46, v158
v_mul_f32 v159, s46, v159
s_sleep 2
L_r4_B0:
global_load_dwordx3 v[36:38], v171, s[38:39] sc1
global_load_dwordx4 v[20:23], v170, s[38:39] sc1
global_load_dwordx4 v[24:27], v170, s[38:39] offset:2048 sc1
s_add_u32 s15, s15, 1
s_cmp_lt_u32 s15, 100000
s_cbranch_scc0 L_fail
s_waitcnt vmcnt(2)
v_max_f32_dpp v142, v36, v36 quad_perm:[1,0,3,2] row_mask:0xf bank_mask:0xf
v_max_u32 v218, v36, v38
s_nop 0
v_max_f32_dpp v142, v142, v142 quad_perm:[2,3,0,1] row_mask:0xf bank_mask:0xf
s_nop 1
v_max_f32_dpp v142, v142, v142 row_half_mirror row_mask:0xf bank_mask:0xf
s_nop 1
v_subrev_f32_dpp v212, v142, v36 row_newbcast:0 row_mask:0xf bank_mask:0xf
v_exp_f32 v212, v212
s_waitcnt vmcnt(1)
v_max3_u32 v218, v218, v20, v21
v_max3_u32 v218, v218, v22, v23
v_perm_b32 v213, v212, v212, s56
v_mul_f32 v143, v212, v38
s_nop 0
v_and_b32_dpp v84, v213, v16 row_newbcast:8 row_mask:0xf bank_mask:0xf
v_and_b32_dpp v85, v213, v17 row_newbcast:8 row_mask:0xf bank_mask:0xf
v_and_b32_dpp v86, v213, v18 row_newbcast:8 row_mask:0xf bank_mask:0xf
v_and_b32_dpp v87, v213, v19 row_newbcast:8 row_mask:0xf bank_mask:0xf
v_and_b32_dpp v88, v213, v16 row_newbcast:9 row_mask:0xf bank_mask:0xf
v_and_b32_dpp v89, v213, v17 row_newbcast:9 row_mask:0xf bank_mask:0xf
v_mfma_f32_16x16x32_bf16 v[40:43], v[84:87], v[20:23], 0
v_and_b32_dpp v90, v213, v18 row_newbcast:9 row_mask:0xf bank_mask:0xf
v_and_b32_dpp v91, v213, v19 row_newbcast:9 row_mask:0xf bank_mask:0xf
v_add_f32_dpp v143, v143, v143 quad_perm:[1,0,3,2] row_mask:0xf bank_mask:0xf
s_waitcnt vmcnt(0)
v_mfma_f32_16x16x32_bf16 v[40:43], v[88:91], v[24:27], v[40:43]
v_max3_u32 v218, v218, v24, v25
v_max3_u32 v218, v218, v26, v27
v_add_f32_dpp v143, v143, v143 quad_perm:[2,3,0,1] row_mask:0xf bank_mask:0xf
v_cmp_eq_u32 vcc, -1, v218
s_nop 0
v_add_f32_dpp v143, v143, v143 row_half_mirror row_mask:0xf bank_mask:0xf
s_cbranch_vccnz L_r4_B0
s_mov_b64 exec, 1
ds_write_b64 v200, v[142:143]
s_mov_b64 exec, -1
v_cvt_pk_bf16_f32 v140, v40, v41
v_cvt_pk_bf16_f32 v141, v42, v43
ds_write2_b32 v191, v140, v141 offset0:0 offset1:8
s_waitcnt lgkmcnt(0)
s_barrier
ds_read_b128 v[84:87], v194 offset:4224
ds_read_b128 v[100:103], v201
ds_read_b128 v[104:107], v202
ds_read_b128 v[88:91], v194 offset:5280
s_mov_b64 exec, s[70:71]
global_store_dword v181, v223, s[28:29] sc1
s_mov_b64 exec, -1
s_waitcnt lgkmcnt(3)
v_smfmac_f32_16x16x64_bf16 v[44:47], v[84:87], a[128:135], v208
s_waitcnt lgkmcnt(1)
v_max3_f32 v212, v100, v102, v104
v_smfmac_f32_16x16x64_bf16 v[48:51], v[84:87], a[144:151], v208
v_max_f32 v212, v212, v106
v_sub_f32 v92, v100, v212
s_waitcnt lgkmcnt(0)
v_smfmac_f32_16x16x64_bf16 v[44:47], v[88:91], a[136:143], v208
v_sub_f32 v93, v102, v212
v_exp_f32 v92, v92
v_smfmac_f32_16x16x64_bf16 v[48:51], v[88:91], a[152:159], v208
v_sub_f32 v94, v104, v212
v_exp_f32 v93, v93
v_smfmac_f32_16x16x64_bf16 v[52:55], v[84:87], a[160:167], v208
v_sub_f32 v95, v106, v212
v_exp_f32 v94, v94
v_smfmac_f32_16x16x64_bf16 v[56:59], v[84:87], a[176:183], v208
v_mul_f32 v213, v92, v101
v_exp_f32 v95, v95
v_smfmac_f32_16x16x64_bf16 v[52:55], v[88:91], a[168:175], v208
v_fma_f32 v213, v93, v103, v213
v_fma_f32 v213, v94, v105, v213
v_smfmac_f32_16x16x64_bf16 v[56:59], v[88:91], a[184:191], v208
v_fma_f32 v213, v95, v107, v213
v_rcp_f32 v213, v213
v_pk_add_f32 v[146:147], v[44:45], v[46:47]
v_pk_add_f32 v[148:149], v[48:49], v[50:51]
v_mul_f32 v146, v146, v92
v_mul_f32 v148, v148, v92
v_fma_f32 v146, v147, v93, v146
v_fma_f32 v148, v149, v93, v148
v_pk_add_f32 v[150:151], v[52:53], v[54:55]
v_pk_add_f32 v[152:153], v[56:57], v[58:59]
v_permlane16_swap_b32 v146, v148
v_mul_f32 v150, v150, v92
v_mul_f32 v152, v152, v92
v_fma_f32 v150, v151, v93, v150
v_fma_f32 v152, v153, v93, v152
v_add_f32 v146, v146, v148
v_fma_f32 v146, v146, v213, v158
v_permlane16_swap_b32 v150, v152
v_add_f32 v150, v150, v152
v_fma_f32 v150, v150, v213, v159
v_cvt_pk_bf16_f32 v212, v146, v150
global_store_dword v176, v212, s[38:39] sc1
s_cmp_eq_u32 s70, 0
s_cbranch_scc1 L_lx_B0
s_lshl_b32 s72, s35, 2
s_lshl_b32 s72, 15, s72
v_add_u32 v166, 262144, v166
s_mov_b32 s70, 0
s_add_u32 s26, s26, 2
s_mov_b64 s[38:39], s[40:41]
s_branch L_lp_B0
L_lx_B0:
s_sub_u32 s26, s26, 2
s_and_b32 s57, s33, 3
s_xor_b32 s57, s57, s31
s_or_b32 s57, s57, s34
s_cmp_eq_u32 s57, 0
s_cbranch_scc0 L_fail
v_add_u32 v166, 131072, v166
s_lshl_b32 s57, s33, 8
s_sub_u32 s57, s57, 4320
v_lshrrev_b32 v215, 1, v192
v_add_u32 v215, s57, v215
v_mov_b32 v216, 1736704
v_mov_b32 v162, s26
v_lshrrev_b32 v212, 2, v210
v_and_b32 v213, 3, v210
v_lshlrev_b32 v214, 4, v210
v_sub_u32 v166, v166, v214
v_lshl_add_u32 v166, v212, 11, v166
v_lshlrev_b32 v213, 4, v213
v_add_u32 v166, v166, v213
s_mul_i32 s57, s30, 1984
v_mov_b32 v214, s57
v_sub_u32 v166, v166, v214
s_lshl_b32 s57, s33, 8
s_lshl_b32 s58, s30, 6
s_add_u32 s57, s57, s58
v_and_b32 v215, 1, v211
v_lshl_add_u32 v215, v215, 3, v213
v_add_u32 v215, s57, v215
s_waitcnt vmcnt(0)
L_r11_B0:
global_load_dwordx4 v[20:23], v166, s[42:43] sc1
global_load_dwordx4 v[24:27], v166, s[42:43] offset:1024 sc1
s_add_u32 s15, s15, 1
s_cmp_lt_u32 s15, 100000
s_cbranch_scc0 L_fail
s_waitcnt vmcnt(1)
v_mfma_f32_16x16x32_bf16 v[40:43], v[4:7], v[20:23], 0
v_max3_u32 v218, v20, v21, v22
v_max_u32 v218, v218, v23
s_waitcnt vmcnt(0)
v_mfma_f32_16x16x32_bf16 v[40:43], v[4:7], v[24:27], v[40:43]
v_max3_u32 v218, v218, v24, v25
v_max3_u32 v218, v218, v26, v27
v_cmp_eq_u32 vcc, -1, v218
s_cbranch_vccnz L_r11_B0
s_nop 3
v_add_f32_dpp v40, v40, v40 row_ror:4 row_mask:0xf bank_mask:0xf
v_add_f32_dpp v41, v41, v41 row_ror:4 row_mask:0xf bank_mask:0xf
v_add_f32_dpp v42, v42, v42 row_ror:4 row_mask:0xf bank_mask:0xf
v_add_f32_dpp v43, v43, v43 row_ror:4 row_mask:0xf bank_mask:0xf
v_add_f32_dpp v40, v40, v40 row_ror:8 row_mask:0xf bank_mask:0xf
v_add_f32_dpp v41, v41, v41 row_ror:8 row_mask:0xf bank_mask:0xf
v_add_f32_dpp v42, v42, v42 row_ror:8 row_mask:0xf bank_mask:0xf
v_add_f32_dpp v43, v43, v43 row_ror:8 row_mask:0xf bank_mask:0xf
v_cvt_pk_bf16_f32 v140, v40, v41
v_cvt_pk_bf16_f32 v141, v42, v43
s_mov_b64 exec, 0xf000f
global_store_dwordx2 v215, v[140:141], s[24:25]
s_or_b32 s57, s33, s30
s_cmp_eq_u32 s57, 0
s_cbranch_scc0 L_fail
s_mov_b64 exec, 1
global_store_dword v216, v162, s[28:29] sc1
s_endpgm
L_fr_B:
s_sleep 1
s_add_u32 s15, s15, 1
s_cmp_lt_u32 s15, 100000
s_cbranch_scc0 L_fail
global_load_dwordx4 v[128:131], v179, s[28:29] sc1
s_waitcnt vmcnt(0)
s_branch L_fc_B
L_cr_B0:
s_sleep 1
s_add_u32 s15, s15, 1
s_cmp_lt_u32 s15, 100000
s_cbranch_scc0 L_fail
global_load_dwordx4 v[20:23], v168, s[38:39] sc1
global_load_dwordx4 v[24:27], v168, s[38:39] offset:1024 sc1
global_load_dwordx4 v[28:31], v168, s[40:41] sc1
global_load_dwordx4 v[32:35], v168, s[40:41] offset:1024 sc1
s_waitcnt vmcnt(0)
s_branch L_cc_B0
L_endB:
s_endpgm
L_post_A1:
s_mov_b32 exec_hi, 0
global_store_dword v172, v217, s[38:39] sc1
s_mov_b32 exec_hi, -1
s_waitcnt vmcnt(8)
s_add_u32 m0, s45, 44048
s_nop 0
global_load_lds_dwordx4 v185, s[8:9] offset:2048 nt
s_waitcnt vmcnt(8)
s_add_u32 m0, s45, 44056
s_nop 0
global_load_lds_dwordx4 v185, s[8:9] offset:3072 nt
s_waitcnt vmcnt(8)
s_add_u32 m0, s45, 48160
v_add_u32 v187, 4096, v185
global_load_lds_dwordx4 v187, s[8:9] offset:0 nt
s_waitcnt vmcnt(8)
s_add_u32 m0, s45, 48168
v_add_u32 v187, 4096, v185
global_load_lds_dwordx4 v187, s[8:9] offset:1024 nt
s_waitcnt vmcnt(8)
s_add_u32 m0, s45, 48176
v_add_u32 v187, 4096, v185
global_load_lds_dwordx4 v187, s[8:9] offset:2048 nt
s_waitcnt vmcnt(8)
s_add_u32 m0, s45, 48184
v_add_u32 v187, 4096, v185
global_load_lds_dwordx4 v187, s[8:9] offset:3072 nt
s_waitcnt vmcnt(8)
s_add_u32 m0, s44, 77312
s_nop 0
global_load_lds_dwordx4 v186, s[12:13] nt
s_waitcnt vmcnt(6)
s_add_u32 m0, s44, 81416
v_add_u32 v187, 16384, v186
global_load_lds_dwordx4 v187, s[12:13] nt
s_waitcnt vmcnt(6)
s_add_u32 m0, s44, 85520
v_add_u32 v187, 32768, v186
global_load_lds_dwordx4 v187, s[12:13] nt
global_load_dwordx4 v[20:23], v167, s[38:39] sc1
global_load_dwordx4 v[24:27], v167, s[38:39] offset:1024 sc1
global_load_dwordx4 v[28:31], v167, s[38:39] offset:2048 sc1
global_load_dwordx4 v[32:35], v167, s[38:39] offset:3072 sc1
s_waitcnt vmcnt(10)
s_add_u32 m0, s44, 89624
v_add_u32 v187, 49152, v186
global_load_lds_dwordx4 v187, s[12:13] nt
s_waitcnt vmcnt(10)
s_add_u32 m0, s44, 93728
v_add_u32 v187, 65536, v186
global_load_lds_dwordx4 v187, s[12:13] nt
s_waitcnt vmcnt(10)
s_add_u32 m0, s44, 97832
v_add_u32 v187, 81920, v186
global_load_lds_dwordx4 v187, s[12:13] nt
s_waitcnt vmcnt(10)
s_add_u32 m0, s44, 101936
v_add_u32 v187, 98304, v186
global_load_lds_dwordx4 v187, s[12:13] nt
s_waitcnt vmcnt(10)
s_add_u32 m0, s44, 106040
v_add_u32 v187, 114688, v186
global_load_lds_dwordx4 v187, s[12:13] nt
s_waitcnt vmcnt(22)
v_xor_b32 v187, 0, v207
ds_read_b128 a[64:67], v187 offset:0
ds_read_b128 a[80:83], v187 offset:256
v_xor_b32 v187, 64, v207
ds_read_b128 a[68:71], v187 offset:0
ds_read_b128 a[84:87], v187 offset:256
v_xor_b32 v187, 128, v207
ds_read_b128 a[72:75], v187 offset:0
ds_read_b128 a[88:91], v187 offset:256
v_xor_b32 v187, 192, v207
ds_read_b128 a[76:79], v187 offset:0
ds_read_b128 a[92:95], v187 offset:256
s_waitcnt vmcnt(12)
s_waitcnt lgkmcnt(0)
s_barrier
ds_read_b64_tr_b16 a[96:97], v206 offset:0
ds_read_b64_tr_b16 a[98:99], v206 offset:512
ds_read_b64_tr_b16 a[100:101], v206 offset:4128
ds_read_b64_tr_b16 a[102:103], v206 offset:4640
ds_read_b64_tr_b16 a[112:113], v206 offset:8
ds_read_b64_tr_b16 a[114:115], v206 offset:520
ds_read_b64_tr_b16 a[116:117], v206 offset:4136
ds_read_b64_tr_b16 a[118:119], v206 offset:4648
ds_read_b64_tr_b16 a[104:105], v206 offset:16640
ds_read_b64_tr_b16 a[106:107], v206 offset:17152
ds_read_b64_tr_b16 a[108:109], v206 offset:20768
ds_read_b64_tr_b16 a[110:111], v206 offset:21280
ds_read_b64_tr_b16 a[120:121], v206 offset:16648
ds_read_b64_tr_b16 a[122:123], v206 offset:17160
ds_read_b64_tr_b16 a[124:125], v206 offset:20776
ds_read_b64_tr_b16 a[126:127], v206 offset:21288
v_mov_b64 v[44:45], 0
v_mov_b64 v[46:47], 0
v_mov_b64 v[48:49], 0
v_mov_b64 v[50:51], 0
v_mov_b64 v[52:53], 0
v_mov_b64 v[54:55], 0
v_mov_b64 v[56:57], 0
v_mov_b64 v[58:59], 0
v_mov_b64 v[68:69], 0
v_mov_b64 v[70:71], 0
v_mov_b64 v[72:73], 0
v_mov_b64 v[74:75], 0
v_mov_b64 v[60:61], 0
v_mov_b64 v[62:63], 0
v_mov_b64 v[64:65], 0
v_mov_b64 v[66:67], 0
s_branch L_c0_A1
L_r0_A1:
s_sleep 1
s_add_u32 s15, s15, 1
s_cmp_lt_u32 s15, 100000
s_cbranch_scc0 L_fail
global_load_dwordx4 v[20:23], v167, s[38:39] sc1
global_load_dwordx4 v[24:27], v167, s[38:39] offset:1024 sc1
global_load_dwordx4 v[28:31], v167, s[38:39] offset:2048 sc1
global_load_dwordx4 v[32:35], v167, s[38:39] offset:3072 sc1
s_waitcnt vmcnt(0)
L_c0_A1:
s_waitcnt vmcnt(8)
v_mfma_f32_16x16x32_bf16 v[40:43], v[8:11], v[20:23], 0
v_max3_u32 v218, v20, v21, v22
v_max_u32 v218, v218, v23
s_waitcnt vmcnt(7)
v_mfma_f32_16x16x32_bf16 v[40:43], v[8:11], v[24:27], v[40:43]
v_max3_u32 v218, v218, v24, v25
v_max3_u32 v218, v218, v26, v27
s_waitcnt vmcnt(6)
v_mfma_f32_16x16x32_bf16 v[40:43], v[12:15], v[28:31], v[40:43]
v_max3_u32 v218, v218, v28, v29
v_max3_u32 v218, v218, v30, v31
s_waitcnt vmcnt(5)
v_mfma_f32_16x16x32_bf16 v[40:43], v[12:15], v[32:35], v[40:43]
v_max3_u32 v218, v218, v32, v33
v_max3_u32 v218, v218, v34, v35
v_cmp_eq_u32 vcc, -1, v218
s_cbranch_vccnz L_r0_A1
s_nop 3
v_cvt_pk_bf16_f32 v140, v40, v41
v_cvt_pk_bf16_f32 v141, v42, v43
ds_write2_b32 v190, v140, v141 offset0:0 offset1:8
s_add_u32 m0, s44, 110144
v_add_u32 v187, 131072, v186
global_load_lds_dwordx4 v187, s[12:13] nt
s_waitcnt lgkmcnt(0)
s_barrier
ds_read_b128 v[84:87], v194 offset:2112
ds_read_b128 v[88:91], v194 offset:3168
s_add_u32 m0, s44, 114248
v_add_u32 v187, 147456, v186
global_load_lds_dwordx4 v187, s[12:13] nt
s_waitcnt lgkmcnt(1)
v_smfmac_f32_16x16x64_bf16 v[60:63], v[84:87], a[64:71], v208
v_smfmac_f32_16x16x64_bf16 v[64:67], v[84:87], a[80:87], v208
s_add_u32 m0, s44, 118352
v_add_u32 v187, 163840, v186
global_load_lds_dwordx4 v187, s[12:13] nt
s_waitcnt lgkmcnt(0)
v_smfmac_f32_16x16x64_bf16 v[60:63], v[88:91], a[72:79], v208
v_smfmac_f32_16x16x64_bf16 v[64:67], v[88:91], a[88:95], v208
s_add_u32 m0, s44, 122456
v_add_u32 v187, 180224, v186
global_load_lds_dwordx4 v187, s[12:13] nt
s_nop 3
v_pk_add_f32 v[146:147], v[60:61], v[62:63]
v_pk_add_f32 v[148:149], v[64:65], v[66:67]
v_max_f32 v164, v146, v148
v_max_f32 v165, v147, v149
s_nop 0
v_max_f32_dpp v164, v164, v164 row_ror:1 row_mask:0xf bank_mask:0xf
v_max_f32_dpp v165, v165, v165 row_ror:1 row_mask:0xf bank_mask:0xf
s_nop 0
v_max_f32_dpp v164, v164, v164 row_ror:2 row_mask:0xf bank_mask:0xf
v_max_f32_dpp v165, v165, v165 row_ror:2 row_mask:0xf bank_mask:0xf
s_nop 0
v_max_f32_dpp v164, v164, v164 row_ror:4 row_mask:0xf bank_mask:0xf
v_max_f32_dpp v165, v165, v165 row_ror:4 row_mask:0xf bank_mask:0xf
s_nop 0
v_max_f32_dpp v164, v164, v164 row_ror:8 row_mask:0xf bank_mask:0xf
v_max_f32_dpp v165, v165, v165 row_ror:8 row_mask:0xf bank_mask:0xf
v_pk_mul_f32 v[164:165], v[164:165], v[144:145] op_sel_hi:[1,0]
v_ceil_f32 v164, v164
v_ceil_f32 v165, v165
v_pk_fma_f32 v[146:147], v[146:147], v[144:145], v[164:165] op_sel_hi:[1,0,1] neg_lo:[0,0,1] neg_hi:[0,0,1]
v_pk_fma_f32 v[148:149], v[148:149], v[144:145], v[164:165] op_sel_hi:[1,0,1] neg_lo:[0,0,1] neg_hi:[0,0,1]
v_exp_f32 v146, v146
v_exp_f32 v148, v148
v_exp_f32 v147, v147
v_exp_f32 v149, v149
v_cvt_pk_bf16_f32 v212, v146, v148
ds_write_b64 v198, v[164:165]
v_cvt_pk_bf16_f32 v213, v147, v149
ds_write2_b32 v197, v212, v213 offset0:0 offset1:4
s_waitcnt lgkmcnt(0)
s_barrier
ds_read_b128 v[84:87], v196 offset:6336
ds_read_b128 v[92:95], v199
ds_read_b128 v[96:99], v199 offset:16
ds_read_b128 v[88:91], v196 offset:7392
s_waitcnt lgkmcnt(3)
v_smfmac_f32_16x16x64_bf16 v[44:47], v[84:87], a[96:103], v208
s_waitcnt lgkmcnt(1)
v_max3_f32 v120, v92, v94, v96
v_max3_f32 v121, v93, v95, v97
v_smfmac_f32_16x16x64_bf16 v[48:51], v[84:87], a[112:119], v208
v_max_f32 v120, v120, v98
v_max_f32 v121, v121, v99
s_waitcnt lgkmcnt(0)
v_smfmac_f32_16x16x64_bf16 v[52:55], v[88:91], a[104:111], v208
v_sub_f32 v92, v92, v120
v_sub_f32 v93, v93, v121
v_smfmac_f32_16x16x64_bf16 v[56:59], v[88:91], a[120:127], v208
v_sub_f32 v94, v94, v120
v_sub_f32 v95, v95, v121
v_smfmac_f32_16x16x64_bf16 v[68:71], v[84:87], v[132:139], v208
v_sub_f32 v96, v96, v120
v_sub_f32 v97, v97, v121
v_smfmac_f32_16x16x64_bf16 v[72:75], v[88:91], v[132:139], v208
v_sub_f32 v98, v98, v120
v_sub_f32 v99, v99, v121
v_exp_f32 v92, v92
v_exp_f32 v93, v93
v_exp_f32 v94, v94
v_exp_f32 v95, v95
v_exp_f32 v96, v96
v_exp_f32 v97, v97
v_exp_f32 v98, v98
v_exp_f32 v99, v99
v_pk_mul_f32 v[146:147], v[44:45], v[92:93]
v_pk_mul_f32 v[148:149], v[48:49], v[92:93]
v_pk_fma_f32 v[146:147], v[46:47], v[94:95], v[146:147]
v_pk_fma_f32 v[148:149], v[50:51], v[94:95], v[148:149]
v_pk_fma_f32 v[146:147], v[52:53], v[96:97], v[146:147]
v_pk_fma_f32 v[148:149], v[56:57], v[96:97], v[148:149]
v_pk_fma_f32 v[146:147], v[54:55], v[98:99], v[146:147]
v_pk_fma_f32 v[148:149], v[58:59], v[98:99], v[148:149]
v_cvt_pk_bf16_f32 v212, v146, v148
v_cvt_pk_bf16_f32 v213, v147, v149
global_store_dword v174, v212, s[38:39] sc1
v_pk_mul_f32 v[122:123], v[68:69], v[92:93]
v_pk_fma_f32 v[122:123], v[70:71], v[94:95], v[122:123]
global_store_dword v174, v213, s[38:39] offset:256 sc1
v_pk_fma_f32 v[122:123], v[72:73], v[96:97], v[122:123]
v_pk_fma_f32 v[122:123], v[74:75], v[98:99], v[122:123]
s_mov_b64 exec, s[48:49]
global_store_dwordx4 v175, v[120:123], s[38:39] sc1
s_mov_b64 exec, -1
v_add_u32 v214, 1056, v193
ds_read2_b32 v[100:101], v193 offset0:0 offset1:4
ds_read2_b32 v[102:103], v193 offset0:132 offset1:136
ds_read2_b32 v[104:105], v214 offset0:0 offset1:4
ds_read2_b32 v[106:107], v214 offset0:132 offset1:136
v_mov_b64 v[44:45], 0
v_mov_b64 v[46:47], 0
v_mov_b64 v[48:49], 0
v_mov_b64 v[50:51], 0
v_mov_b64 v[52:53], 0
v_mov_b64 v[54:55], 0
v_mov_b64 v[56:57], 0
v_mov_b64 v[58:59], 0
s_waitcnt lgkmcnt(0)
v_pk_add_f32 v[100:101], v[100:101], v[102:103]
v_pk_add_f32 v[104:105], v[104:105], v[106:107]
v_pk_add_f32 v[100:101], v[100:101], v[104:105]
v_cvt_pk_bf16_f32 v214, v100, v101
v_lshlrev_b32 v158, 16, v214
v_and_b32 v159, 0xffff0000, v214
v_mul_f32 v158, s46, v158
v_mul_f32 v159, s46, v159
s_waitcnt vmcnt(9)
s_add_u32 m0, s44, 126560
v_add_u32 v187, 196608, v186
global_load_lds_dwordx4 v187, s[12:13] nt
s_waitcnt vmcnt(9)
s_add_u32 m0, s44, 130664
v_add_u32 v187, 212992, v186
global_load_lds_dwordx4 v187, s[12:13] nt
s_waitcnt vmcnt(9)
s_add_u32 m0, s44, 134768
v_add_u32 v187, 229376, v186
global_load_lds_dwordx4 v187, s[12:13] nt
s_waitcnt vmcnt(9)
s_add_u32 m0, s44, 138872
v_add_u32 v187, 245760, v186
global_load_lds_dwordx4 v187, s[12:13] nt
s_waitcnt vmcnt(11)
s_waitcnt lgkmcnt(0)
s_barrier
ds_read_b64_tr_b16 a[128:129], v204 offset:0
ds_read_b64_tr_b16 a[130:131], v204 offset:2048
ds_read_b64_tr_b16 a[144:145], v205 offset:0
ds_read_b64_tr_b16 a[146:147], v205 offset:2048
ds_read_b64_tr_b16 a[160:161], v204 offset:8
ds_read_b64_tr_b16 a[162:163], v204 offset:2056
ds_read_b64_tr_b16 a[176:177], v205 offset:8
ds_read_b64_tr_b16 a[178:179], v205 offset:2056
ds_read_b64_tr_b16 a[132:133], v204 offset:16416
ds_read_b64_tr_b16 a[134:135], v204 offset:18464
ds_read_b64_tr_b16 a[148:149], v205 offset:16416
ds_read_b64_tr_b16 a[150:151], v205 offset:18464
ds_read_b64_tr_b16 a[164:165], v204 offset:16424
ds_read_b64_tr_b16 a[166:167], v204 offset:18472
ds_read_b64_tr_b16 a[180:181], v205 offset:16424
ds_read_b64_tr_b16 a[182:183], v205 offset:18472
global_load_dwordx3 v[36:38], v171, s[38:39] sc1
global_load_dwordx4 v[20:23], v170, s[38:39] sc1
global_load_dwordx4 v[24:27], v170, s[38:39] offset:2048 sc1
s_waitcnt vmcnt(10)
s_waitcnt lgkmcnt(0)
s_barrier
ds_read_b64_tr_b16 a[136:137], v204 offset:32832
ds_read_b64_tr_b16 a[138:139], v204 offset:34880
ds_read_b64_tr_b16 a[152:153], v205 offset:32832
ds_read_b64_tr_b16 a[154:155], v205 offset:34880
ds_read_b64_tr_b16 a[168:169], v204 offset:32840
ds_read_b64_tr_b16 a[170:171], v204 offset:34888
ds_read_b64_tr_b16 a[184:185], v205 offset:32840
ds_read_b64_tr_b16 a[186:187], v205 offset:34888
s_waitcnt vmcnt(3)
s_waitcnt lgkmcnt(0)
s_barrier
ds_read_b64_tr_b16 a[140:141], v204 offset:49248
ds_read_b64_tr_b16 a[142:143], v204 offset:51296
ds_read_b64_tr_b16 a[156:157], v205 offset:49248
ds_read_b64_tr_b16 a[158:159], v205 offset:51296
ds_read_b64_tr_b16 a[172:173], v204 offset:49256
ds_read_b64_tr_b16 a[174:175], v204 offset:51304
ds_read_b64_tr_b16 a[188:189], v205 offset:49256
ds_read_b64_tr_b16 a[190:191], v205 offset:51304
s_branch L_c1_A1
L_r1_A1:
s_sleep 1
s_add_u32 s15, s15, 1
s_cmp_lt_u32 s15, 100000
s_cbranch_scc0 L_fail
global_load_dwordx3 v[36:38], v171, s[38:39] sc1
global_load_dwordx4 v[20:23], v170, s[38:39] sc1
global_load_dwordx4 v[24:27], v170, s[38:39] offset:2048 sc1
s_waitcnt vmcnt(0)
L_c1_A1:
s_waitcnt vmcnt(2)
v_max_f32_dpp v142, v36, v36 quad_perm:[1,0,3,2] row_mask:0xf bank_mask:0xf
v_max_u32 v218, v36, v38
s_nop 0
v_max_f32_dpp v142, v142, v142 quad_perm:[2,3,0,1] row_mask:0xf bank_mask:0xf
s_nop 1
v_max_f32_dpp v142, v142, v142 row_half_mirror row_mask:0xf bank_mask:0xf
s_nop 1
v_subrev_f32_dpp v212, v142, v36 row_newbcast:0 row_mask:0xf bank_mask:0xf
v_exp_f32 v212, v212
s_waitcnt vmcnt(1)
v_max3_u32 v218, v218, v20, v21
v_max3_u32 v218, v218, v22, v23
v_perm_b32 v213, v212, v212, s56
v_mul_f32 v143, v212, v38
s_nop 0
v_and_b32_dpp v84, v213, v16 row_newbcast:8 row_mask:0xf bank_mask:0xf
v_and_b32_dpp v85, v213, v17 row_newbcast:8 row_mask:0xf bank_mask:0xf
v_and_b32_dpp v86, v213, v18 row_newbcast:8 row_mask:0xf bank_mask:0xf
v_and_b32_dpp v87, v213, v19 row_newbcast:8 row_mask:0xf bank_mask:0xf
v_and_b32_dpp v88, v213, v16 row_newbcast:9 row_mask:0xf bank_mask:0xf
v_and_b32_dpp v89, v213, v17 row_newbcast:9 row_mask:0xf bank_mask:0xf
v_mfma_f32_16x16x32_bf16 v[40:43], v[84:87], v[20:23], 0
v_and_b32_dpp v90, v213, v18 row_newbcast:9 row_mask:0xf bank_mask:0xf
v_and_b32_dpp v91, v213, v19 row_newbcast:9 row_mask:0xf bank_mask:0xf
v_add_f32_dpp v143, v143, v143 quad_perm:[1,0,3,2] row_mask:0xf bank_mask:0xf
s_waitcnt vmcnt(0)
v_mfma_f32_16x16x32_bf16 v[40:43], v[88:91], v[24:27], v[40:43]
v_max3_u32 v218, v218, v24, v25
v_max3_u32 v218, v218, v26, v27
v_add_f32_dpp v143, v143, v143 quad_perm:[2,3,0,1] row_mask:0xf bank_mask:0xf
v_cmp_eq_u32 vcc, -1, v218
s_nop 0
v_add_f32_dpp v143, v143, v143 row_half_mirror row_mask:0xf bank_mask:0xf
s_cbranch_vccnz L_r1_A1
s_mov_b64 exec, 1
ds_write_b64 v200, v[142:143]
s_mov_b64 exec, -1
v_cvt_pk_bf16_f32 v140, v40, v41
v_cvt_pk_bf16_f32 v141, v42, v43
ds_write2_b32 v191, v140, v141 offset0:0 offset1:8
s_waitcnt lgkmcnt(0)
s_barrier
ds_read_b128 v[84:87], v194 offset:4224
ds_read_b128 v[100:103], v201
ds_read_b128 v[104:107], v202
ds_read_b128 v[88:91], v194 offset:5280
s_mov_b64 exec, 3
global_store_dword v181, v223, s[28:29] sc1
s_mov_b64 exec, -1
s_waitcnt lgkmcnt(3)
v_smfmac_f32_16x16x64_bf16 v[44:47], v[84:87], a[128:135], v208
s_waitcnt lgkmcnt(1)
v_max3_f32 v212, v100, v102, v104
v_smfmac_f32_16x16x64_bf16 v[48:51], v[84:87], a[144:151], v208
v_max_f32 v212, v212, v106
v_sub_f32 v92, v100, v212
s_waitcnt lgkmcnt(0)
v_smfmac_f32_16x16x64_bf16 v[44:47], v[88:91], a[136:143], v208
v_sub_f32 v93, v102, v212
v_exp_f32 v92, v92
v_smfmac_f32_16x16x64_bf16 v[48:51], v[88:91], a[152:159], v208
v_sub_f32 v94, v104, v212
v_exp_f32 v93, v93
v_smfmac_f32_16x16x64_bf16 v[52:55], v[84:87], a[160:167], v208
v_sub_f32 v95, v106, v212
v_exp_f32 v94, v94
v_smfmac_f32_16x16x64_bf16 v[56:59], v[84:87], a[176:183], v208
v_mul_f32 v213, v92, v101
v_exp_f32 v95, v95
v_smfmac_f32_16x16x64_bf16 v[52:55], v[88:91], a[168:175], v208
v_fma_f32 v213, v93, v103, v213
v_fma_f32 v213, v94, v105, v213
v_smfmac_f32_16x16x64_bf16 v[56:59], v[88:91], a[184:191], v208
v_fma_f32 v213, v95, v107, v213
v_rcp_f32 v213, v213
v_pk_add_f32 v[146:147], v[44:45], v[46:47]
v_pk_add_f32 v[148:149], v[48:49], v[50:51]
v_mul_f32 v146, v146, v92
v_mul_f32 v148, v148, v92
v_fma_f32 v146, v147, v93, v146
v_fma_f32 v148, v149, v93, v148
v_pk_add_f32 v[150:151], v[52:53], v[54:55]
v_pk_add_f32 v[152:153], v[56:57], v[58:59]
v_permlane16_swap_b32 v146, v148
v_mul_f32 v150, v150, v92
v_mul_f32 v152, v152, v92
v_fma_f32 v150, v151, v93, v150
v_fma_f32 v152, v153, v93, v152
v_add_f32 v146, v146, v148
v_fma_f32 v146, v146, v213, v158
v_permlane16_swap_b32 v150, v152
v_add_f32 v150, v150, v152
v_fma_f32 v150, v150, v213, v159
v_cvt_pk_bf16_f32 v212, v146, v150
global_store_dword v176, v212, s[38:39] sc1
global_load_dwordx4 v[128:131], v179, s[28:29] sc1
global_load_dword v218, v178, s[40:41] sc1
s_waitcnt vmcnt(1)
v_xor_b32 v212, s26, v128
v_cmp_ne_u32 s[60:61], s54, v212
v_cmp_eq_u32 vcc, s26, v130
s_nop 1
v_cndmask_b32 v213, 0, v131, vcc
v_cmp_lt_i32 s[58:59], 0, v213
v_cmp_gt_i32 vcc, 0, v213
v_mov_b32 v160, s60
s_nop 1
s_bcnt1_i32_b64 s58, s[58:59]
s_bcnt1_i32_b64 s59, vcc
s_sub_u32 s58, s58, s59
v_mov_b32 v161, s58
ds_write_b64 v203, v[160:161]
v_mov_b64 v[44:45], 0
v_mov_b64 v[46:47], 0
v_mov_b64 v[48:49], 0
v_mov_b64 v[50:51], 0
v_mov_b64 v[52:53], 0
v_mov_b64 v[54:55], 0
v_mov_b64 v[56:57], 0
v_mov_b64 v[58:59], 0
ds_read_b128 v[84:87], v194 offset:0
ds_read_b128 v[88:91], v194 offset:1056
s_waitcnt lgkmcnt(0)
v_smfmac_f32_16x16x64_bf16 v[44:47], v[84:87], a[0:7], v208
v_smfmac_f32_16x16x64_bf16 v[48:51], v[84:87], a[16:23], v208
s_waitcnt lgkmcnt(0)
v_smfmac_f32_16x16x64_bf16 v[44:47], v[88:91], a[8:15], v208
v_smfmac_f32_16x16x64_bf16 v[48:51], v[88:91], a[24:31], v208
v_smfmac_f32_16x16x64_bf16 v[52:55], v[84:87], a[32:39], v208
v_smfmac_f32_16x16x64_bf16 v[56:59], v[84:87], a[48:55], v208
v_smfmac_f32_16x16x64_bf16 v[52:55], v[88:91], a[40:47], v208
v_smfmac_f32_16x16x64_bf16 v[56:59], v[88:91], a[56:63], v208
s_nop 2
v_pk_add_f32 v[146:147], v[44:45], v[46:47]
v_add_f32 v146, v146, v147
v_pk_add_f32 v[148:149], v[48:49], v[50:51]
v_add_f32 v148, v148, v149
v_pk_add_f32 v[150:151], v[52:53], v[54:55]
v_add_f32 v150, v150, v151
v_pk_add_f32 v[152:153], v[56:57], v[58:59]
v_add_f32 v152, v152, v153
v_permlane16_swap_b32 v146, v148
v_add_f32 v146, v146, v148
v_permlane16_swap_b32 v150, v152
v_add_f32 v150, v150, v152
v_cvt_pk_bf16_f32 v212, v146, v150
s_mov_b32 exec_lo, 0
global_store_dword v172, v212, s[38:39] sc1
s_mov_b32 exec_lo, -1
global_load_dwordx4 v[20:23], v168, s[38:39] sc1
global_load_dwordx4 v[24:27], v168, s[38:39] offset:1024 sc1
global_load_dwordx4 v[28:31], v168, s[40:41] sc1
global_load_dwordx4 v[32:35], v168, s[40:41] offset:1024 sc1
v_mov_b64 v[60:61], 0
v_mov_b64 v[62:63], 0
v_mov_b64 v[64:65], 0
v_mov_b64 v[66:67], 0
L_cc_A1:
s_waitcnt vmcnt(3)
v_mfma_f32_16x16x32_bf16 v[40:43], v[8:11], v[20:23], 0
v_max3_u32 v218, v20, v21, v22
v_max_u32 v218, v218, v23
s_waitcnt vmcnt(2)
v_mfma_f32_16x16x32_bf16 v[40:43], v[8:11], v[24:27], v[40:43]
v_max3_u32 v218, v218, v24, v25
v_max3_u32 v218, v218, v26, v27
s_waitcnt vmcnt(1)
v_mfma_f32_16x16x32_bf16 v[40:43], v[12:15], v[28:31], v[40:43]
v_max3_u32 v218, v218, v28, v29
v_max3_u32 v218, v218, v30, v31
s_waitcnt vmcnt(0)
v_mfma_f32_16x16x32_bf16 v[40:43], v[12:15], v[32:35], v[40:43]
v_max3_u32 v218, v218, v32, v33
v_max3_u32 v218, v218, v34, v35
v_cmp_eq_u32 vcc, -1, v218
s_cbranch_vccnz L_cr_A1
s_nop 3
v_cvt_pk_bf16_f32 v140, v40, v41
v_cvt_pk_bf16_f32 v141, v42, v43
ds_write2_b32 v190, v140, v141 offset0:0 offset1:8
s_waitcnt lgkmcnt(0)
s_barrier
ds_read_b128 v[84:87], v194 offset:2112
ds_read_b128 v[88:91], v194 offset:3168
s_waitcnt lgkmcnt(0)
v_smfmac_f32_16x16x64_bf16 v[60:63], v[84:87], a[64:71], v208
v_smfmac_f32_16x16x64_bf16 v[64:67], v[84:87], a[80:87], v208
v_smfmac_f32_16x16x64_bf16 v[60:63], v[88:91], a[72:79], v208
v_smfmac_f32_16x16x64_bf16 v[64:67], v[88:91], a[88:95], v208
s_nop 6
v_pk_add_f32 v[154:155], v[60:61], v[62:63]
v_pk_add_f32 v[156:157], v[64:65], v[66:67]
v_mov_b32 v214, 8608
ds_read_b128 v[100:103], v214
ds_read_b128 v[104:107], v214 offset:16
s_waitcnt lgkmcnt(0)
v_or3_b32 v214, v100, v102, v104
v_add3_u32 v215, v101, v103, v105
v_or_b32 v214, v214, v106
v_add_u32 v215, v215, v107
v_readfirstlane_b32 s37, v214
v_readfirstlane_b32 s72, v215
s_cmp_gt_i32 s72, 0
s_cselect_b32 s57, 1, 0
s_xor_b32 s57, s57, s55
s_lshl_b32 s57, s57, 13
s_add_u32 s42, s28, s57
s_addc_u32 s43, s29, 0
s_branch L_al_A1
.p2align 6
L_al_A1:
s_add_u32 s47, s26, 2
s_cmp_eq_u32 s30, 0
s_cbranch_scc0 L_db2_A1
s_mov_b64 exec, 15
global_load_dword v219, v182, s[42:43] offset:0 sc1
s_sleep 1
global_load_dword v220, v182, s[42:43] offset:128 sc1
s_sleep 1
global_load_dword v221, v182, s[42:43] offset:256 sc1
s_sleep 1
global_load_dword v222, v182, s[42:43] offset:384 sc1
s_sleep 1
L_dp2_A1:
s_waitcnt vmcnt(3)
v_cmp_ne_u32 vcc, s47, v219
s_cbranch_vccz L_dd2_A1
global_load_dword v219, v182, s[42:43] offset:0 sc1
s_sleep 1
s_waitcnt vmcnt(3)
v_cmp_ne_u32 vcc, s47, v220
s_cbranch_vccz L_dd2_A1
global_load_dword v220, v182, s[42:43] offset:128 sc1
s_sleep 1
s_waitcnt vmcnt(3)
v_cmp_ne_u32 vcc, s47, v221
s_cbranch_vccz L_dd2_A1
global_load_dword v221, v182, s[42:43] offset:256 sc1
s_sleep 1
s_waitcnt vmcnt(3)
v_cmp_ne_u32 vcc, s47, v222
s_cbranch_vccz L_dd2_A1
global_load_dword v222, v182, s[42:43] offset:384 sc1
s_sleep 1
s_add_u32 s15, s15, 1
s_cmp_lt_u32 s15, 100000
s_cbranch_scc1 L_dp2_A1
s_branch L_fail
L_dd2_A1:
s_mov_b64 exec, -1
L_db2_A1:
s_barrier
L_r5_A1:
global_load_dwordx4 v[20:23], v166, s[42:43] sc1
global_load_dwordx4 v[24:27], v166, s[42:43] offset:1024 sc1
s_add_u32 s15, s15, 1
s_cmp_lt_u32 s15, 100000
s_cbranch_scc0 L_fail
v_mov_b64 v[44:45], 0
v_mov_b64 v[46:47], 0
v_mov_b64 v[48:49], 0
v_mov_b64 v[50:51], 0
v_mov_b64 v[52:53], 0
v_mov_b64 v[54:55], 0
v_mov_b64 v[56:57], 0
v_mov_b64 v[58:59], 0
s_waitcnt vmcnt(1)
v_mfma_f32_16x16x32_bf16 v[40:43], v[4:7], v[20:23], 0
v_max3_u32 v218, v20, v21, v22
v_max_u32 v218, v218, v23
s_waitcnt vmcnt(0)
v_mfma_f32_16x16x32_bf16 v[40:43], v[4:7], v[24:27], v[40:43]
v_max3_u32 v218, v218, v24, v25
v_max3_u32 v218, v218, v26, v27
v_cmp_eq_u32 vcc, -1, v218
s_cbranch_vccnz L_r5_A1
s_nop 3
v_cvt_pk_bf16_f32 v140, v40, v41
v_cvt_pk_bf16_f32 v141, v42, v43
ds_write2_b32 v189, v140, v141 offset0:0 offset1:8
s_waitcnt lgkmcnt(0)
s_barrier
ds_read_b128 v[80:83], v195 offset:0
ds_read_b128 v[84:87], v194 offset:0
ds_read_b128 v[88:91], v194 offset:1056
s_waitcnt lgkmcnt(2)
v_mfma_f32_16x16x32_bf16 v[76:79], v[80:83], v[80:83], 0
s_waitcnt lgkmcnt(1)
v_smfmac_f32_16x16x64_bf16 v[44:47], v[84:87], a[0:7], v208
v_smfmac_f32_16x16x64_bf16 v[48:51], v[84:87], a[16:23], v208
s_waitcnt lgkmcnt(0)
v_smfmac_f32_16x16x64_bf16 v[44:47], v[88:91], a[8:15], v208
s_nop 2
v_add_f32 v142, v76, v77
v_add_f32 v143, v78, v79
v_smfmac_f32_16x16x64_bf16 v[48:51], v[88:91], a[24:31], v208
v_cndmask_b32 v142, v142, v143, s[50:51]
v_smfmac_f32_16x16x64_bf16 v[52:55], v[84:87], a[32:39], v208
v_add_f32 v146, v44, v46
v_add_f32_dpp v142, v142, v142 quad_perm:[1,0,3,2] row_mask:0xf bank_mask:0xf
v_smfmac_f32_16x16x64_bf16 v[56:59], v[84:87], a[48:55], v208
v_add_f32 v147, v45, v47
v_add_f32_dpp v142, v142, v142 quad_perm:[2,3,0,1] row_mask:0xf bank_mask:0xf
v_smfmac_f32_16x16x64_bf16 v[52:55], v[88:91], a[40:47], v208
v_add_f32 v146, v146, v147
v_add_f32_dpp v142, v142, v142 row_half_mirror row_mask:0xf bank_mask:0xf
v_smfmac_f32_16x16x64_bf16 v[56:59], v[88:91], a[56:63], v208
v_add_f32 v148, v48, v50
v_add_f32 v149, v49, v51
v_add_f32 v148, v148, v149
s_mov_b64 exec, s[52:53]
global_store_dword v173, v142, s[40:41] sc1
s_mov_b64 exec, -1
v_pk_add_f32 v[150:151], v[52:53], v[54:55]
v_permlane16_swap_b32 v146, v148
v_pk_add_f32 v[152:153], v[56:57], v[58:59]
v_add_f32 v150, v150, v151
v_add_f32 v152, v152, v153
v_add_f32 v146, v146, v148
s_mov_b32 exec_hi, 0
v_permlane16_swap_b32 v150, v152
v_add_f32 v150, v150, v152
v_cvt_pk_bf16_f32 v212, v146, v150
global_store_dword v172, v212, s[40:41] sc1
s_mov_b32 exec_hi, -1
ds_write_b128 v192, v[40:43]
s_add_u32 s57, s26, 3
v_mov_b32 v223, s57
s_sleep 3
L_r6_A1:
global_load_dwordx4 v[20:23], v167, s[40:41] sc1
global_load_dwordx4 v[24:27], v167, s[40:41] offset:1024 sc1
global_load_dwordx4 v[28:31], v167, s[40:41] offset:2048 sc1
global_load_dwordx4 v[32:35], v167, s[40:41] offset:3072 sc1
global_load_dwordx4 v[36:39], v169, s[40:41] sc1
s_add_u32 s15, s15, 1
s_cmp_lt_u32 s15, 100000
s_cbranch_scc0 L_fail
v_mov_b64 v[44:45], 0
v_mov_b64 v[46:47], 0
v_mov_b64 v[48:49], 0
v_mov_b64 v[50:51], 0
v_mov_b64 v[52:53], 0
v_mov_b64 v[54:55], 0
v_mov_b64 v[56:57], 0
v_mov_b64 v[58:59], 0
v_mov_b64 v[68:69], 0
v_mov_b64 v[70:71], 0
v_mov_b64 v[72:73], 0
v_mov_b64 v[74:75], 0
v_mov_b64 v[62:63], 0
v_mov_b64 v[66:67], 0
s_waitcnt vmcnt(4)
v_mfma_f32_16x16x32_bf16 v[40:43], v[8:11], v[20:23], 0
v_max3_u32 v218, v20, v21, v22
v_max_u32 v218, v218, v23
s_waitcnt vmcnt(3)
v_mfma_f32_16x16x32_bf16 v[40:43], v[8:11], v[24:27], v[40:43]
v_max3_u32 v218, v218, v24, v25
v_max3_u32 v218, v218, v26, v27
s_waitcnt vmcnt(2)
v_mfma_f32_16x16x32_bf16 v[40:43], v[12:15], v[28:31], v[40:43]
v_max3_u32 v218, v218, v28, v29
v_max3_u32 v218, v218, v30, v31
s_waitcnt vmcnt(1)
v_mfma_f32_16x16x32_bf16 v[40:43], v[12:15], v[32:35], v[40:43]
v_max3_u32 v218, v218, v32, v33
v_max3_u32 v218, v218, v34, v35
s_waitcnt vmcnt(0)
v_max3_u32 v218, v218, v36, v37
v_max_u32 v218, v218, v38
v_cmp_eq_u32 vcc, -1, v218
s_cbranch_vccnz L_r6_A1
s_nop 0
v_cvt_pk_bf16_f32 v140, v40, v41
v_cvt_pk_bf16_f32 v141, v42, v43
ds_write2_b32 v190, v140, v141 offset0:0 offset1:8
v_add_f32 v142, v36, v37
v_add_f32_dpp v143, v38, v38 row_ror:1 row_mask:0xf bank_mask:0xf
s_nop 0
v_add_f32_dpp v142, v142, v142 row_ror:1 row_mask:0xf bank_mask:0xf
v_add_f32_dpp v143, v143, v143 row_ror:2 row_mask:0xf bank_mask:0xf
s_waitcnt lgkmcnt(0)
s_barrier
ds_read_b128 v[84:87], v194 offset:2112
ds_read_b128 v[88:91], v194 offset:3168
v_add_f32_dpp v142, v142, v142 row_ror:2 row_mask:0xf bank_mask:0xf
v_add_f32_dpp v143, v143, v143 row_ror:4 row_mask:0xf bank_mask:0xf
s_nop 0
v_add_f32_dpp v142, v142, v142 row_ror:4 row_mask:0xf bank_mask:0xf
v_add_f32_dpp v143, v143, v143 row_ror:8 row_mask:0xf bank_mask:0xf
s_nop 0
v_add_f32_dpp v142, v142, v142 row_ror:8 row_mask:0xf bank_mask:0xf
v_mul_f32 v145, 0xba800000, v143
v_pk_mul_f32 v[60:61], v[154:155], v[144:145] op_sel:[0,1] op_sel_hi:[1,1]
v_pk_mul_f32 v[64:65], v[156:157], v[144:145] op_sel:[0,1] op_sel_hi:[1,1]
s_waitcnt lgkmcnt(1)
v_smfmac_f32_16x16x64_bf16 v[60:63], v[84:87], a[64:71], v208
v_mul_f32 v212, v145, v145
v_mul_f32 v213, 0x3a800000, v142
v_smfmac_f32_16x16x64_bf16 v[64:67], v[84:87], a[80:87], v208
v_sub_f32 v213, v213, v212
v_max_f32 v213, 0, v213
s_waitcnt lgkmcnt(0)
v_smfmac_f32_16x16x64_bf16 v[60:63], v[88:91], a[72:79], v208
v_add_f32 v213, 0x3727c5ac, v213
v_rsq_f32 v213, v213
v_smfmac_f32_16x16x64_bf16 v[64:67], v[88:91], a[88:95], v208
v_mul_f32 v144, 0x3e0293ee, v213
s_nop 3
v_pk_add_f32 v[146:147], v[60:61], v[62:63]
s_nop 1
v_pk_add_f32 v[148:149], v[64:65], v[66:67]
v_max_f32 v164, v146, v148
v_max_f32 v165, v147, v149
s_nop 0
v_max_f32_dpp v164, v164, v164 row_ror:1 row_mask:0xf bank_mask:0xf
v_max_f32_dpp v165, v165, v165 row_ror:1 row_mask:0xf bank_mask:0xf
s_nop 0
v_max_f32_dpp v164, v164, v164 row_ror:2 row_mask:0xf bank_mask:0xf
v_max_f32_dpp v165, v165, v165 row_ror:2 row_mask:0xf bank_mask:0xf
s_nop 0
v_max_f32_dpp v164, v164, v164 row_ror:4 row_mask:0xf bank_mask:0xf
v_max_f32_dpp v165, v165, v165 row_ror:4 row_mask:0xf bank_mask:0xf
s_nop 0
v_max_f32_dpp v164, v164, v164 row_ror:8 row_mask:0xf bank_mask:0xf
v_max_f32_dpp v165, v165, v165 row_ror:8 row_mask:0xf bank_mask:0xf
v_pk_mul_f32 v[164:165], v[164:165], v[144:145] op_sel_hi:[1,0]
v_ceil_f32 v164, v164
v_ceil_f32 v165, v165
v_pk_fma_f32 v[146:147], v[146:147], v[144:145], v[164:165] op_sel_hi:[1,0,1] neg_lo:[0,0,1] neg_hi:[0,0,1]
v_pk_fma_f32 v[148:149], v[148:149], v[144:145], v[164:165] op_sel_hi:[1,0,1] neg_lo:[0,0,1] neg_hi:[0,0,1]
v_exp_f32 v146, v146
v_exp_f32 v148, v148
v_exp_f32 v147, v147
v_exp_f32 v149, v149
v_cvt_pk_bf16_f32 v212, v146, v148
ds_write_b64 v198, v[164:165]
v_cvt_pk_bf16_f32 v213, v147, v149
ds_write2_b32 v197, v212, v213 offset0:0 offset1:4
s_waitcnt lgkmcnt(0)
s_barrier
ds_read_b128 v[84:87], v196 offset:6336
ds_read_b128 v[92:95], v199
ds_read_b128 v[96:99], v199 offset:16
ds_read_b128 v[88:91], v196 offset:7392
s_waitcnt lgkmcnt(3)
v_smfmac_f32_16x16x64_bf16 v[44:47], v[84:87], a[96:103], v208
s_waitcnt lgkmcnt(1)
v_max3_f32 v120, v92, v94, v96
v_max3_f32 v121, v93, v95, v97
v_smfmac_f32_16x16x64_bf16 v[48:51], v[84:87], a[112:119], v208
v_max_f32 v120, v120, v98
v_max_f32 v121, v121, v99
s_waitcnt lgkmcnt(0)
v_smfmac_f32_16x16x64_bf16 v[52:55], v[88:91], a[104:111], v208
v_sub_f32 v92, v92, v120
v_sub_f32 v93, v93, v121
v_smfmac_f32_16x16x64_bf16 v[56:59], v[88:91], a[120:127], v208
v_sub_f32 v94, v94, v120
v_sub_f32 v95, v95, v121
v_smfmac_f32_16x16x64_bf16 v[68:71], v[84:87], v[132:139], v208
v_sub_f32 v96, v96, v120
v_sub_f32 v97, v97, v121
v_smfmac_f32_16x16x64_bf16 v[72:75], v[88:91], v[132:139], v208
v_sub_f32 v98, v98, v120
v_sub_f32 v99, v99, v121
v_exp_f32 v92, v92
v_exp_f32 v93, v93
v_exp_f32 v94, v94
v_exp_f32 v95, v95
v_exp_f32 v96, v96
v_exp_f32 v97, v97
v_exp_f32 v98, v98
v_exp_f32 v99, v99
v_pk_mul_f32 v[146:147], v[44:45], v[92:93]
v_pk_mul_f32 v[148:149], v[48:49], v[92:93]
v_pk_fma_f32 v[146:147], v[46:47], v[94:95], v[146:147]
v_pk_fma_f32 v[148:149], v[50:51], v[94:95], v[148:149]
v_pk_fma_f32 v[146:147], v[52:53], v[96:97], v[146:147]
v_pk_fma_f32 v[148:149], v[56:57], v[96:97], v[148:149]
v_pk_fma_f32 v[146:147], v[54:55], v[98:99], v[146:147]
v_pk_fma_f32 v[148:149], v[58:59], v[98:99], v[148:149]
v_cvt_pk_bf16_f32 v212, v146, v148
v_cvt_pk_bf16_f32 v213, v147, v149
global_store_dword v174, v212, s[40:41] sc1
v_pk_mul_f32 v[122:123], v[68:69], v[92:93]
v_pk_fma_f32 v[122:123], v[70:71], v[94:95], v[122:123]
global_store_dword v174, v213, s[40:41] offset:256 sc1
v_pk_fma_f32 v[122:123], v[72:73], v[96:97], v[122:123]
v_pk_fma_f32 v[122:123], v[74:75], v[98:99], v[122:123]
s_mov_b64 exec, s[48:49]
global_store_dwordx4 v175, v[120:123], s[40:41] sc1
s_mov_b64 exec, -1
v_add_u32 v214, 1056, v193
ds_read2_b32 v[100:101], v193 offset0:0 offset1:4
ds_read2_b32 v[102:103], v193 offset0:132 offset1:136
ds_read2_b32 v[104:105], v214 offset0:0 offset1:4
ds_read2_b32 v[106:107], v214 offset0:132 offset1:136
v_mov_b64 v[44:45], 0
v_mov_b64 v[46:47], 0
v_mov_b64 v[48:49], 0
v_mov_b64 v[50:51], 0
v_mov_b64 v[52:53], 0
v_mov_b64 v[54:55], 0
v_mov_b64 v[56:57], 0
v_mov_b64 v[58:59], 0
s_waitcnt lgkmcnt(0)
v_pk_add_f32 v[100:101], v[100:101], v[102:103]
v_pk_add_f32 v[104:105], v[104:105], v[106:107]
v_pk_add_f32 v[100:101], v[100:101], v[104:105]
v_cvt_pk_bf16_f32 v214, v100, v101
v_lshlrev_b32 v158, 16, v214
v_and_b32 v159, 0xffff0000, v214
v_mul_f32 v158, s46, v158
v_mul_f32 v159, s46, v159
s_sleep 2
L_r7_A1:
global_load_dwordx3 v[36:38], v171, s[40:41] sc1
global_load_dwordx4 v[20:23], v170, s[40:41] sc1
global_load_dwordx4 v[24:27], v170, s[40:41] offset:2048 sc1
s_add_u32 s15, s15, 1
s_cmp_lt_u32 s15, 100000
s_cbranch_scc0 L_fail
s_waitcnt vmcnt(2)
v_max_f32_dpp v142, v36, v36 quad_perm:[1,0,3,2] row_mask:0xf bank_mask:0xf
v_max_u32 v218, v36, v38
s_nop 0
v_max_f32_dpp v142, v142, v142 quad_perm:[2,3,0,1] row_mask:0xf bank_mask:0xf
s_nop 1
v_max_f32_dpp v142, v142, v142 row_half_mirror row_mask:0xf bank_mask:0xf
s_nop 1
v_subrev_f32_dpp v212, v142, v36 row_newbcast:0 row_mask:0xf bank_mask:0xf
v_exp_f32 v212, v212
s_waitcnt vmcnt(1)
v_max3_u32 v218, v218, v20, v21
v_max3_u32 v218, v218, v22, v23
v_perm_b32 v213, v212, v212, s56
v_mul_f32 v143, v212, v38
s_nop 0
v_and_b32_dpp v84, v213, v16 row_newbcast:8 row_mask:0xf bank_mask:0xf
v_and_b32_dpp v85, v213, v17 row_newbcast:8 row_mask:0xf bank_mask:0xf
v_and_b32_dpp v86, v213, v18 row_newbcast:8 row_mask:0xf bank_mask:0xf
v_and_b32_dpp v87, v213, v19 row_newbcast:8 row_mask:0xf bank_mask:0xf
v_and_b32_dpp v88, v213, v16 row_newbcast:9 row_mask:0xf bank_mask:0xf
v_and_b32_dpp v89, v213, v17 row_newbcast:9 row_mask:0xf bank_mask:0xf
v_mfma_f32_16x16x32_bf16 v[40:43], v[84:87], v[20:23], 0
v_and_b32_dpp v90, v213, v18 row_newbcast:9 row_mask:0xf bank_mask:0xf
v_and_b32_dpp v91, v213, v19 row_newbcast:9 row_mask:0xf bank_mask:0xf
v_add_f32_dpp v143, v143, v143 quad_perm:[1,0,3,2] row_mask:0xf bank_mask:0xf
s_waitcnt vmcnt(0)
v_mfma_f32_16x16x32_bf16 v[40:43], v[88:91], v[24:27], v[40:43]
v_max3_u32 v218, v218, v24, v25
v_max3_u32 v218, v218, v26, v27
v_add_f32_dpp v143, v143, v143 quad_perm:[2,3,0,1] row_mask:0xf bank_mask:0xf
v_cmp_eq_u32 vcc, -1, v218
s_nop 0
v_add_f32_dpp v143, v143, v143 row_half_mirror row_mask:0xf bank_mask:0xf
s_cbranch_vccnz L_r7_A1
s_mov_b64 exec, 1
ds_write_b64 v200, v[142:143]
s_mov_b64 exec, -1
v_cvt_pk_bf16_f32 v140, v40, v41
v_cvt_pk_bf16_f32 v141, v42, v43
ds_write2_b32 v191, v140, v141 offset0:0 offset1:8
s_waitcnt lgkmcnt(0)
s_barrier
ds_read_b128 v[84:87], v194 offset:4224
ds_read_b128 v[100:103], v201
ds_read_b128 v[104:107], v202
ds_read_b128 v[88:91], v194 offset:5280
s_mov_b64 exec, 3
global_store_dword v181, v223, s[28:29] sc1
s_mov_b64 exec, -1
s_waitcnt lgkmcnt(3)
v_smfmac_f32_16x16x64_bf16 v[44:47], v[84:87], a[128:135], v208
s_waitcnt lgkmcnt(1)
v_max3_f32 v212, v100, v102, v104
v_smfmac_f32_16x16x64_bf16 v[48:51], v[84:87], a[144:151], v208
v_max_f32 v212, v212, v106
v_sub_f32 v92, v100, v212
s_waitcnt lgkmcnt(0)
v_smfmac_f32_16x16x64_bf16 v[44:47], v[88:91], a[136:143], v208
v_sub_f32 v93, v102, v212
v_exp_f32 v92, v92
v_smfmac_f32_16x16x64_bf16 v[48:51], v[88:91], a[152:159], v208
v_sub_f32 v94, v104, v212
v_exp_f32 v93, v93
v_smfmac_f32_16x16x64_bf16 v[52:55], v[84:87], a[160:167], v208
v_sub_f32 v95, v106, v212
v_exp_f32 v94, v94
v_smfmac_f32_16x16x64_bf16 v[56:59], v[84:87], a[176:183], v208
v_mul_f32 v213, v92, v101
v_exp_f32 v95, v95
v_smfmac_f32_16x16x64_bf16 v[52:55], v[88:91], a[168:175], v208
v_fma_f32 v213, v93, v103, v213
v_fma_f32 v213, v94, v105, v213
v_smfmac_f32_16x16x64_bf16 v[56:59], v[88:91], a[184:191], v208
v_fma_f32 v213, v95, v107, v213
v_rcp_f32 v213, v213
v_pk_add_f32 v[146:147], v[44:45], v[46:47]
v_pk_add_f32 v[148:149], v[48:49], v[50:51]
v_mul_f32 v146, v146, v92
v_mul_f32 v148, v148, v92
v_fma_f32 v146, v147, v93, v146
v_fma_f32 v148, v149, v93, v148
v_pk_add_f32 v[150:151], v[52:53], v[54:55]
v_pk_add_f32 v[152:153], v[56:57], v[58:59]
v_permlane16_swap_b32 v146, v148
v_mul_f32 v150, v150, v92
v_mul_f32 v152, v152, v92
v_fma_f32 v150, v151, v93, v150
v_fma_f32 v152, v153, v93, v152
v_add_f32 v146, v146, v148
v_fma_f32 v146, v146, v213, v158
v_permlane16_swap_b32 v150, v152
v_add_f32 v150, v150, v152
v_fma_f32 v150, v150, v213, v159
v_cvt_pk_bf16_f32 v212, v146, v150
global_store_dword v176, v212, s[40:41] sc1
s_endpgm
L_cr_A1:
s_sleep 1
s_add_u32 s15, s15, 1
s_cmp_lt_u32 s15, 100000
s_cbranch_scc0 L_fail
global_load_dwordx4 v[20:23], v168, s[38:39] sc1
global_load_dwordx4 v[24:27], v168, s[38:39] offset:1024 sc1
global_load_dwordx4 v[28:31], v168, s[40:41] sc1
global_load_dwordx4 v[32:35], v168, s[40:41] offset:1024 sc1
s_waitcnt vmcnt(0)
s_branch L_cc_A1
L_post_B1:
s_add_u32 m0, s3, 15360
v_xor_b32 v187, 160, v184
v_add_u32 v187, 4096, v187
global_load_lds_dwordx4 v187, s[16:17] offset:1024 nt
v_mov_b64 v[44:45], 0
v_mov_b64 v[46:47], 0
v_mov_b64 v[48:49], 0
v_mov_b64 v[50:51], 0
v_mov_b64 v[52:53], 0
v_mov_b64 v[54:55], 0
v_mov_b64 v[56:57], 0
v_mov_b64 v[58:59], 0
ds_read_b128 v[84:87], v194 offset:0
ds_read_b128 v[88:91], v194 offset:1056
s_waitcnt lgkmcnt(0)
v_smfmac_f32_16x16x64_bf16 v[44:47], v[84:87], a[0:7], v208
v_smfmac_f32_16x16x64_bf16 v[48:51], v[84:87], a[16:23], v208
s_waitcnt lgkmcnt(0)
v_smfmac_f32_16x16x64_bf16 v[44:47], v[88:91], a[8:15], v208
v_smfmac_f32_16x16x64_bf16 v[48:51], v[88:91], a[24:31], v208
v_smfmac_f32_16x16x64_bf16 v[52:55], v[84:87], a[32:39], v208
v_smfmac_f32_16x16x64_bf16 v[56:59], v[84:87], a[48:55], v208
v_smfmac_f32_16x16x64_bf16 v[52:55], v[88:91], a[40:47], v208
v_smfmac_f32_16x16x64_bf16 v[56:59], v[88:91], a[56:63], v208
s_nop 2
v_pk_add_f32 v[146:147], v[44:45], v[46:47]
v_add_f32 v146, v146, v147
v_pk_add_f32 v[148:149], v[48:49], v[50:51]
v_add_f32 v148, v148, v149
v_pk_add_f32 v[150:151], v[52:53], v[54:55]
v_add_f32 v150, v150, v151
v_pk_add_f32 v[152:153], v[56:57], v[58:59]
v_add_f32 v152, v152, v153
v_permlane16_swap_b32 v146, v148
v_add_f32 v146, v146, v148
v_permlane16_swap_b32 v150, v152
v_add_f32 v150, v150, v152
v_cvt_pk_bf16_f32 v212, v146, v150
s_mov_b32 exec_lo, 0
global_store_dword v172, v212, s[38:39] sc1
s_mov_b32 exec_lo, -1
s_waitcnt vmcnt(5)
v_xor_b32 v187, 192, v184
v_add_u32 v187, 4096, v187
global_load_lds_dwordx4 v187, s[16:17] offset:2048 nt
s_waitcnt vmcnt(5)
v_xor_b32 v187, 224, v184
v_add_u32 v187, 4096, v187
global_load_lds_dwordx4 v187, s[16:17] offset:3072 nt
s_waitcnt vmcnt(5)
s_add_u32 m0, s45, 44032
s_nop 0
global_load_lds_dwordx4 v185, s[18:19] offset:0 nt
s_waitcnt vmcnt(5)
s_add_u32 m0, s45, 44040
s_nop 0
global_load_lds_dwordx4 v185, s[18:19] offset:1024 nt
s_waitcnt vmcnt(5)
s_add_u32 m0, s45, 44048
s_nop 0
global_load_lds_dwordx4 v185, s[18:19] offset:2048 nt
s_waitcnt vmcnt(4)
s_add_u32 m0, s45, 44056
s_nop 0
global_load_lds_dwordx4 v185, s[18:19] offset:3072 nt
s_waitcnt vmcnt(4)
s_add_u32 m0, s45, 48160
v_add_u32 v187, 4096, v185
global_load_lds_dwordx4 v187, s[18:19] offset:0 nt
s_waitcnt vmcnt(5)
v_xor_b32 v187, 0, v207
ds_read_b128 a[64:67], v187 offset:0
ds_read_b128 a[80:83], v187 offset:256
v_xor_b32 v187, 64, v207
ds_read_b128 a[68:71], v187 offset:0
ds_read_b128 a[84:87], v187 offset:256
v_xor_b32 v187, 128, v207
ds_read_b128 a[72:75], v187 offset:0
ds_read_b128 a[88:91], v187 offset:256
v_xor_b32 v187, 192, v207
ds_read_b128 a[76:79], v187 offset:0
ds_read_b128 a[92:95], v187 offset:256
s_waitcnt vmcnt(10)
s_add_u32 m0, s45, 48168
v_add_u32 v187, 4096, v185
global_load_lds_dwordx4 v187, s[18:19] offset:1024 nt
s_waitcnt vmcnt(10)
s_add_u32 m0, s45, 48176
v_add_u32 v187, 4096, v185
global_load_lds_dwordx4 v187, s[18:19] offset:2048 nt
s_waitcnt vmcnt(10)
s_add_u32 m0, s45, 48184
v_add_u32 v187, 4096, v185
global_load_lds_dwordx4 v187, s[18:19] offset:3072 nt
s_waitcnt vmcnt(9)
s_add_u32 m0, s44, 77312
s_nop 0
global_load_lds_dwordx4 v186, s[22:23] nt
s_waitcnt vmcnt(9)
s_add_u32 m0, s44, 81416
v_add_u32 v187, 16384, v186
global_load_lds_dwordx4 v187, s[22:23] nt
s_waitcnt vmcnt(9)
s_add_u32 m0, s44, 85520
v_add_u32 v187, 32768, v186
global_load_lds_dwordx4 v187, s[22:23] nt
s_waitcnt vmcnt(9)
s_add_u32 m0, s44, 89624
v_add_u32 v187, 49152, v186
global_load_lds_dwordx4 v187, s[22:23] nt
s_waitcnt vmcnt(9)
s_add_u32 m0, s44, 93728
v_add_u32 v187, 65536, v186
global_load_lds_dwordx4 v187, s[22:23] nt
s_waitcnt vmcnt(9)
s_add_u32 m0, s44, 97832
v_add_u32 v187, 81920, v186
global_load_lds_dwordx4 v187, s[22:23] nt
s_waitcnt vmcnt(9)
s_add_u32 m0, s44, 101936
v_add_u32 v187, 98304, v186
global_load_lds_dwordx4 v187, s[22:23] nt
s_waitcnt vmcnt(9)
s_add_u32 m0, s44, 106040
v_add_u32 v187, 114688, v186
global_load_lds_dwordx4 v187, s[22:23] nt
s_waitcnt vmcnt(9)
s_add_u32 m0, s44, 110144
v_add_u32 v187, 131072, v186
global_load_lds_dwordx4 v187, s[22:23] nt
s_waitcnt vmcnt(9)
s_add_u32 m0, s44, 114248
v_add_u32 v187, 147456, v186
global_load_lds_dwordx4 v187, s[22:23] nt
s_waitcnt vmcnt(10)
s_waitcnt lgkmcnt(0)
s_barrier
ds_read_b64_tr_b16 a[96:97], v206 offset:0
ds_read_b64_tr_b16 a[98:99], v206 offset:512
ds_read_b64_tr_b16 a[100:101], v206 offset:4128
ds_read_b64_tr_b16 a[102:103], v206 offset:4640
ds_read_b64_tr_b16 a[112:113], v206 offset:8
ds_read_b64_tr_b16 a[114:115], v206 offset:520
ds_read_b64_tr_b16 a[116:117], v206 offset:4136
ds_read_b64_tr_b16 a[118:119], v206 offset:4648
ds_read_b64_tr_b16 a[104:105], v206 offset:16640
ds_read_b64_tr_b16 a[106:107], v206 offset:17152
ds_read_b64_tr_b16 a[108:109], v206 offset:20768
ds_read_b64_tr_b16 a[110:111], v206 offset:21280
ds_read_b64_tr_b16 a[120:121], v206 offset:16648
ds_read_b64_tr_b16 a[122:123], v206 offset:17160
ds_read_b64_tr_b16 a[124:125], v206 offset:20776
ds_read_b64_tr_b16 a[126:127], v206 offset:21288
global_load_dwordx4 v[20:23], v168, s[38:39] sc1
global_load_dwordx4 v[24:27], v168, s[38:39] offset:1024 sc1
global_load_dwordx4 v[28:31], v168, s[40:41] sc1
global_load_dwordx4 v[32:35], v168, s[40:41] offset:1024 sc1
s_waitcnt vmcnt(13)
s_add_u32 m0, s44, 118352
v_add_u32 v187, 163840, v186
global_load_lds_dwordx4 v187, s[22:23] nt
s_waitcnt vmcnt(13)
s_add_u32 m0, s44, 122456
v_add_u32 v187, 180224, v186
global_load_lds_dwordx4 v187, s[22:23] nt
s_waitcnt vmcnt(13)
s_add_u32 m0, s44, 126560
v_add_u32 v187, 196608, v186
global_load_lds_dwordx4 v187, s[22:23] nt
s_waitcnt vmcnt(13)
s_add_u32 m0, s44, 130664
v_add_u32 v187, 212992, v186
global_load_lds_dwordx4 v187, s[22:23] nt
s_waitcnt vmcnt(13)
s_add_u32 m0, s44, 134768
v_add_u32 v187, 229376, v186
global_load_lds_dwordx4 v187, s[22:23] nt
s_waitcnt vmcnt(13)
s_add_u32 m0, s44, 138872
v_add_u32 v187, 245760, v186
global_load_lds_dwordx4 v187, s[22:23] nt
s_waitcnt vmcnt(12)
s_waitcnt lgkmcnt(0)
s_barrier
ds_read_b64_tr_b16 a[128:129], v204 offset:0
ds_read_b64_tr_b16 a[130:131], v204 offset:2048
ds_read_b64_tr_b16 a[144:145], v205 offset:0
ds_read_b64_tr_b16 a[146:147], v205 offset:2048
ds_read_b64_tr_b16 a[160:161], v204 offset:8
ds_read_b64_tr_b16 a[162:163], v204 offset:2056
ds_read_b64_tr_b16 a[176:177], v205 offset:8
ds_read_b64_tr_b16 a[178:179], v205 offset:2056
ds_read_b64_tr_b16 a[132:133], v204 offset:16416
ds_read_b64_tr_b16 a[134:135], v204 offset:18464
ds_read_b64_tr_b16 a[148:149], v205 offset:16416
ds_read_b64_tr_b16 a[150:151], v205 offset:18464
ds_read_b64_tr_b16 a[164:165], v204 offset:16424
ds_read_b64_tr_b16 a[166:167], v204 offset:18472
ds_read_b64_tr_b16 a[180:181], v205 offset:16424
ds_read_b64_tr_b16 a[182:183], v205 offset:18472
v_mov_b64 v[60:61], 0
v_mov_b64 v[62:63], 0
v_mov_b64 v[64:65], 0
v_mov_b64 v[66:67], 0
L_cc_B1:
s_waitcnt vmcnt(9)
v_mfma_f32_16x16x32_bf16 v[40:43], v[8:11], v[20:23], 0
v_max3_u32 v218, v20, v21, v22
v_max_u32 v218, v218, v23
s_waitcnt vmcnt(8)
v_mfma_f32_16x16x32_bf16 v[40:43], v[8:11], v[24:27], v[40:43]
v_max3_u32 v218, v218, v24, v25
v_max3_u32 v218, v218, v26, v27
s_waitcnt vmcnt(7)
v_mfma_f32_16x16x32_bf16 v[40:43], v[12:15], v[28:31], v[40:43]
v_max3_u32 v218, v218, v28, v29
v_max3_u32 v218, v218, v30, v31
s_waitcnt vmcnt(6)
v_mfma_f32_16x16x32_bf16 v[40:43], v[12:15], v[32:35], v[40:43]
v_max3_u32 v218, v218, v32, v33
v_max3_u32 v218, v218, v34, v35
v_cmp_eq_u32 vcc, -1, v218
s_cbranch_vccnz L_cr_B1
s_nop 3
v_cvt_pk_bf16_f32 v140, v40, v41
v_cvt_pk_bf16_f32 v141, v42, v43
ds_write2_b32 v190, v140, v141 offset0:0 offset1:8
s_waitcnt lgkmcnt(0)
s_barrier
ds_read_b128 v[84:87], v194 offset:2112
ds_read_b128 v[88:91], v194 offset:3168
s_waitcnt lgkmcnt(0)
v_smfmac_f32_16x16x64_bf16 v[60:63], v[84:87], a[64:71], v208
v_smfmac_f32_16x16x64_bf16 v[64:67], v[84:87], a[80:87], v208
v_smfmac_f32_16x16x64_bf16 v[60:63], v[88:91], a[72:79], v208
v_smfmac_f32_16x16x64_bf16 v[64:67], v[88:91], a[88:95], v208
s_nop 6
v_pk_add_f32 v[154:155], v[60:61], v[62:63]
v_pk_add_f32 v[156:157], v[64:65], v[66:67]
s_waitcnt vmcnt(4)
s_waitcnt lgkmcnt(0)
s_barrier
ds_read_b64_tr_b16 a[136:137], v204 offset:32832
ds_read_b64_tr_b16 a[138:139], v204 offset:34880
ds_read_b64_tr_b16 a[152:153], v205 offset:32832
ds_read_b64_tr_b16 a[154:155], v205 offset:34880
ds_read_b64_tr_b16 a[168:169], v204 offset:32840
ds_read_b64_tr_b16 a[170:171], v204 offset:34888
ds_read_b64_tr_b16 a[184:185], v205 offset:32840
ds_read_b64_tr_b16 a[186:187], v205 offset:34888
s_waitcnt vmcnt(0)
s_waitcnt lgkmcnt(0)
s_barrier
ds_read_b64_tr_b16 a[140:141], v204 offset:49248
ds_read_b64_tr_b16 a[142:143], v204 offset:51296
ds_read_b64_tr_b16 a[156:157], v205 offset:49248
ds_read_b64_tr_b16 a[158:159], v205 offset:51296
ds_read_b64_tr_b16 a[172:173], v204 offset:49256
ds_read_b64_tr_b16 a[174:175], v204 offset:51304
ds_read_b64_tr_b16 a[188:189], v205 offset:49256
ds_read_b64_tr_b16 a[190:191], v205 offset:51304
s_branch L_al_B1
.p2align 6
s_nop 0
s_nop 0
s_nop 0
L_al_B1:
s_mov_b32 s72, -1
s_mov_b32 s73, 0
s_mov_b64 s[70:71], 3
L_lp_B1:
s_add_u32 s47, s26, 1
s_cmp_eq_u32 s30, 0
s_cbranch_scc0 L_db1_B1
s_mov_b64 exec, s[72:73]
global_load_dword v219, v182, s[42:43] offset:0 sc1
s_sleep 1
global_load_dword v220, v182, s[42:43] offset:128 sc1
s_sleep 1
global_load_dword v221, v182, s[42:43] offset:256 sc1
s_sleep 1
global_load_dword v222, v182, s[42:43] offset:384 sc1
s_sleep 1
L_dp1_B1:
s_waitcnt vmcnt(3)
v_cmp_ne_u32 vcc, s47, v219
s_cbranch_vccz L_dd1_B1
global_load_dword v219, v182, s[42:43] offset:0 sc1
s_sleep 1
s_waitcnt vmcnt(3)
v_cmp_ne_u32 vcc, s47, v220
s_cbranch_vccz L_dd1_B1
global_load_dword v220, v182, s[42:43] offset:128 sc1
s_sleep 1
s_waitcnt vmcnt(3)
v_cmp_ne_u32 vcc, s47, v221
s_cbranch_vccz L_dd1_B1
global_load_dword v221, v182, s[42:43] offset:256 sc1
s_sleep 1
s_waitcnt vmcnt(3)
v_cmp_ne_u32 vcc, s47, v222
s_cbranch_vccz L_dd1_B1
global_load_dword v222, v182, s[42:43] offset:384 sc1
s_sleep 1
s_add_u32 s15, s15, 1
s_cmp_lt_u32 s15, 100000
s_cbranch_scc1 L_dp1_B1
s_branch L_fail
L_dd1_B1:
s_mov_b64 exec, -1
L_db1_B1:
s_barrier
L_r2_B1:
global_load_dwordx4 v[20:23], v166, s[42:43] sc1
global_load_dwordx4 v[24:27], v166, s[42:43] offset:1024 sc1
s_add_u32 s15, s15, 1
s_cmp_lt_u32 s15, 100000
s_cbranch_scc0 L_fail
v_mov_b64 v[44:45], 0
v_mov_b64 v[46:47], 0
v_mov_b64 v[48:49], 0
v_mov_b64 v[50:51], 0
v_mov_b64 v[52:53], 0
v_mov_b64 v[54:55], 0
v_mov_b64 v[56:57], 0
v_mov_b64 v[58:59], 0
s_waitcnt vmcnt(1)
v_mfma_f32_16x16x32_bf16 v[40:43], v[4:7], v[20:23], 0
v_max3_u32 v218, v20, v21, v22
v_max_u32 v218, v218, v23
s_waitcnt vmcnt(0)
v_mfma_f32_16x16x32_bf16 v[40:43], v[4:7], v[24:27], v[40:43]
v_max3_u32 v218, v218, v24, v25
v_max3_u32 v218, v218, v26, v27
v_cmp_eq_u32 vcc, -1, v218
s_cbranch_vccnz L_r2_B1
s_nop 3
v_cvt_pk_bf16_f32 v140, v40, v41
v_cvt_pk_bf16_f32 v141, v42, v43
ds_write2_b32 v189, v140, v141 offset0:0 offset1:8
s_waitcnt lgkmcnt(0)
s_barrier
ds_read_b128 v[80:83], v195 offset:0
ds_read_b128 v[84:87], v194 offset:0
ds_read_b128 v[88:91], v194 offset:1056
s_waitcnt lgkmcnt(2)
v_mfma_f32_16x16x32_bf16 v[76:79], v[80:83], v[80:83], 0
s_waitcnt lgkmcnt(1)
v_smfmac_f32_16x16x64_bf16 v[44:47], v[84:87], a[0:7], v208
v_smfmac_f32_16x16x64_bf16 v[48:51], v[84:87], a[16:23], v208
s_waitcnt lgkmcnt(0)
v_smfmac_f32_16x16x64_bf16 v[44:47], v[88:91], a[8:15], v208
s_nop 2
v_add_f32 v142, v76, v77
v_add_f32 v143, v78, v79
v_smfmac_f32_16x16x64_bf16 v[48:51], v[88:91], a[24:31], v208
v_cndmask_b32 v142, v142, v143, s[50:51]
v_smfmac_f32_16x16x64_bf16 v[52:55], v[84:87], a[32:39], v208
v_add_f32 v146, v44, v46
v_add_f32_dpp v142, v142, v142 quad_perm:[1,0,3,2] row_mask:0xf bank_mask:0xf
v_smfmac_f32_16x16x64_bf16 v[56:59], v[84:87], a[48:55], v208
v_add_f32 v147, v45, v47
v_add_f32_dpp v142, v142, v142 quad_perm:[2,3,0,1] row_mask:0xf bank_mask:0xf
v_smfmac_f32_16x16x64_bf16 v[52:55], v[88:91], a[40:47], v208
v_add_f32 v146, v146, v147
v_add_f32_dpp v142, v142, v142 row_half_mirror row_mask:0xf bank_mask:0xf
v_smfmac_f32_16x16x64_bf16 v[56:59], v[88:91], a[56:63], v208
v_add_f32 v148, v48, v50
v_add_f32 v149, v49, v51
v_add_f32 v148, v148, v149
s_mov_b64 exec, s[52:53]
global_store_dword v173, v142, s[38:39] sc1
s_mov_b64 exec, -1
v_pk_add_f32 v[150:151], v[52:53], v[54:55]
v_permlane16_swap_b32 v146, v148
v_pk_add_f32 v[152:153], v[56:57], v[58:59]
v_add_f32 v150, v150, v151
v_add_f32 v152, v152, v153
v_add_f32 v146, v146, v148
s_mov_b32 exec_hi, 0
v_permlane16_swap_b32 v150, v152
v_add_f32 v150, v150, v152
v_cvt_pk_bf16_f32 v212, v146, v150
global_store_dword v172, v212, s[38:39] sc1
s_mov_b32 exec_hi, -1
ds_write_b128 v192, v[40:43]
s_add_u32 s57, s26, 2
v_mov_b32 v223, s57
s_sleep 3
L_r3_B1:
global_load_dwordx4 v[20:23], v167, s[38:39] sc1
global_load_dwordx4 v[24:27], v167, s[38:39] offset:1024 sc1
global_load_dwordx4 v[28:31], v167, s[38:39] offset:2048 sc1
global_load_dwordx4 v[32:35], v167, s[38:39] offset:3072 sc1
global_load_dwordx4 v[36:39], v169, s[38:39] sc1
s_add_u32 s15, s15, 1
s_cmp_lt_u32 s15, 100000
s_cbranch_scc0 L_fail
v_mov_b64 v[44:45], 0
v_mov_b64 v[46:47], 0
v_mov_b64 v[48:49], 0
v_mov_b64 v[50:51], 0
v_mov_b64 v[52:53], 0
v_mov_b64 v[54:55], 0
v_mov_b64 v[56:57], 0
v_mov_b64 v[58:59], 0
v_mov_b64 v[68:69], 0
v_mov_b64 v[70:71], 0
v_mov_b64 v[72:73], 0
v_mov_b64 v[74:75], 0
v_mov_b64 v[62:63], 0
v_mov_b64 v[66:67], 0
s_waitcnt vmcnt(4)
v_mfma_f32_16x16x32_bf16 v[40:43], v[8:11], v[20:23], 0
v_max3_u32 v218, v20, v21, v22
v_max_u32 v218, v218, v23
s_waitcnt vmcnt(3)
v_mfma_f32_16x16x32_bf16 v[40:43], v[8:11], v[24:27], v[40:43]
v_max3_u32 v218, v218, v24, v25
v_max3_u32 v218, v218, v26, v27
s_waitcnt vmcnt(2)
v_mfma_f32_16x16x32_bf16 v[40:43], v[12:15], v[28:31], v[40:43]
v_max3_u32 v218, v218, v28, v29
v_max3_u32 v218, v218, v30, v31
s_waitcnt vmcnt(1)
v_mfma_f32_16x16x32_bf16 v[40:43], v[12:15], v[32:35], v[40:43]
v_max3_u32 v218, v218, v32, v33
v_max3_u32 v218, v218, v34, v35
s_waitcnt vmcnt(0)
v_max3_u32 v218, v218, v36, v37
v_max_u32 v218, v218, v38
v_cmp_eq_u32 vcc, -1, v218
s_cbranch_vccnz L_r3_B1
s_nop 0
v_cvt_pk_bf16_f32 v140, v40, v41
v_cvt_pk_bf16_f32 v141, v42, v43
ds_write2_b32 v190, v140, v141 offset0:0 offset1:8
v_add_f32 v142, v36, v37
v_add_f32_dpp v143, v38, v38 row_ror:1 row_mask:0xf bank_mask:0xf
s_nop 0
v_add_f32_dpp v142, v142, v142 row_ror:1 row_mask:0xf bank_mask:0xf
v_add_f32_dpp v143, v143, v143 row_ror:2 row_mask:0xf bank_mask:0xf
s_waitcnt lgkmcnt(0)
s_barrier
ds_read_b128 v[84:87], v194 offset:2112
ds_read_b128 v[88:91], v194 offset:3168
v_add_f32_dpp v142, v142, v142 row_ror:2 row_mask:0xf bank_mask:0xf
v_add_f32_dpp v143, v143, v143 row_ror:4 row_mask:0xf bank_mask:0xf
s_nop 0
v_add_f32_dpp v142, v142, v142 row_ror:4 row_mask:0xf bank_mask:0xf
v_add_f32_dpp v143, v143, v143 row_ror:8 row_mask:0xf bank_mask:0xf
s_nop 0
v_add_f32_dpp v142, v142, v142 row_ror:8 row_mask:0xf bank_mask:0xf
v_mul_f32 v145, 0xba800000, v143
v_pk_mul_f32 v[60:61], v[154:155], v[144:145] op_sel:[0,1] op_sel_hi:[1,1]
v_pk_mul_f32 v[64:65], v[156:157], v[144:145] op_sel:[0,1] op_sel_hi:[1,1]
s_waitcnt lgkmcnt(1)
v_smfmac_f32_16x16x64_bf16 v[60:63], v[84:87], a[64:71], v208
v_mul_f32 v212, v145, v145
v_mul_f32 v213, 0x3a800000, v142
v_smfmac_f32_16x16x64_bf16 v[64:67], v[84:87], a[80:87], v208
v_sub_f32 v213, v213, v212
v_max_f32 v213, 0, v213
s_waitcnt lgkmcnt(0)
v_smfmac_f32_16x16x64_bf16 v[60:63], v[88:91], a[72:79], v208
v_add_f32 v213, 0x3727c5ac, v213
v_rsq_f32 v213, v213
v_smfmac_f32_16x16x64_bf16 v[64:67], v[88:91], a[88:95], v208
v_mul_f32 v144, 0x3e0293ee, v213
s_nop 3
v_pk_add_f32 v[146:147], v[60:61], v[62:63]
s_nop 1
v_pk_add_f32 v[148:149], v[64:65], v[66:67]
v_max_f32 v164, v146, v148
v_max_f32 v165, v147, v149
s_nop 0
v_max_f32_dpp v164, v164, v164 row_ror:1 row_mask:0xf bank_mask:0xf
v_max_f32_dpp v165, v165, v165 row_ror:1 row_mask:0xf bank_mask:0xf
s_nop 0
v_max_f32_dpp v164, v164, v164 row_ror:2 row_mask:0xf bank_mask:0xf
v_max_f32_dpp v165, v165, v165 row_ror:2 row_mask:0xf bank_mask:0xf
s_nop 0
v_max_f32_dpp v164, v164, v164 row_ror:4 row_mask:0xf bank_mask:0xf
v_max_f32_dpp v165, v165, v165 row_ror:4 row_mask:0xf bank_mask:0xf
s_nop 0
v_max_f32_dpp v164, v164, v164 row_ror:8 row_mask:0xf bank_mask:0xf
v_max_f32_dpp v165, v165, v165 row_ror:8 row_mask:0xf bank_mask:0xf
v_pk_mul_f32 v[164:165], v[164:165], v[144:145] op_sel_hi:[1,0]
v_ceil_f32 v164, v164
v_ceil_f32 v165, v165
v_pk_fma_f32 v[146:147], v[146:147], v[144:145], v[164:165] op_sel_hi:[1,0,1] neg_lo:[0,0,1] neg_hi:[0,0,1]
v_pk_fma_f32 v[148:149], v[148:149], v[144:145], v[164:165] op_sel_hi:[1,0,1] neg_lo:[0,0,1] neg_hi:[0,0,1]
v_exp_f32 v146, v146
v_exp_f32 v148, v148
v_exp_f32 v147, v147
v_exp_f32 v149, v149
v_cvt_pk_bf16_f32 v212, v146, v148
ds_write_b64 v198, v[164:165]
v_cvt_pk_bf16_f32 v213, v147, v149
ds_write2_b32 v197, v212, v213 offset0:0 offset1:4
s_waitcnt lgkmcnt(0)
s_barrier
ds_read_b128 v[84:87], v196 offset:6336
ds_read_b128 v[92:95], v199
ds_read_b128 v[96:99], v199 offset:16
ds_read_b128 v[88:91], v196 offset:7392
s_waitcnt lgkmcnt(3)
v_smfmac_f32_16x16x64_bf16 v[44:47], v[84:87], a[96:103], v208
s_waitcnt lgkmcnt(1)
v_max3_f32 v120, v92, v94, v96
v_max3_f32 v121, v93, v95, v97
v_smfmac_f32_16x16x64_bf16 v[48:51], v[84:87], a[112:119], v208
v_max_f32 v120, v120, v98
v_max_f32 v121, v121, v99
s_waitcnt lgkmcnt(0)
v_smfmac_f32_16x16x64_bf16 v[52:55], v[88:91], a[104:111], v208
v_sub_f32 v92, v92, v120
v_sub_f32 v93, v93, v121
v_smfmac_f32_16x16x64_bf16 v[56:59], v[88:91], a[120:127], v208
v_sub_f32 v94, v94, v120
v_sub_f32 v95, v95, v121
v_smfmac_f32_16x16x64_bf16 v[68:71], v[84:87], v[132:139], v208
v_sub_f32 v96, v96, v120
v_sub_f32 v97, v97, v121
v_smfmac_f32_16x16x64_bf16 v[72:75], v[88:91], v[132:139], v208
v_sub_f32 v98, v98, v120
v_sub_f32 v99, v99, v121
v_exp_f32 v92, v92
v_exp_f32 v93, v93
v_exp_f32 v94, v94
v_exp_f32 v95, v95
v_exp_f32 v96, v96
v_exp_f32 v97, v97
v_exp_f32 v98, v98
v_exp_f32 v99, v99
v_pk_mul_f32 v[146:147], v[44:45], v[92:93]
v_pk_mul_f32 v[148:149], v[48:49], v[92:93]
v_pk_fma_f32 v[146:147], v[46:47], v[94:95], v[146:147]
v_pk_fma_f32 v[148:149], v[50:51], v[94:95], v[148:149]
v_pk_fma_f32 v[146:147], v[52:53], v[96:97], v[146:147]
v_pk_fma_f32 v[148:149], v[56:57], v[96:97], v[148:149]
v_pk_fma_f32 v[146:147], v[54:55], v[98:99], v[146:147]
v_pk_fma_f32 v[148:149], v[58:59], v[98:99], v[148:149]
v_cvt_pk_bf16_f32 v212, v146, v148
v_cvt_pk_bf16_f32 v213, v147, v149
global_store_dword v174, v212, s[38:39] sc1
v_pk_mul_f32 v[122:123], v[68:69], v[92:93]
v_pk_fma_f32 v[122:123], v[70:71], v[94:95], v[122:123]
global_store_dword v174, v213, s[38:39] offset:256 sc1
v_pk_fma_f32 v[122:123], v[72:73], v[96:97], v[122:123]
v_pk_fma_f32 v[122:123], v[74:75], v[98:99], v[122:123]
s_mov_b64 exec, s[48:49]
global_store_dwordx4 v175, v[120:123], s[38:39] sc1
s_mov_b64 exec, -1
v_add_u32 v214, 1056, v193
ds_read2_b32 v[100:101], v193 offset0:0 offset1:4
ds_read2_b32 v[102:103], v193 offset0:132 offset1:136
ds_read2_b32 v[104:105], v214 offset0:0 offset1:4
ds_read2_b32 v[106:107], v214 offset0:132 offset1:136
v_mov_b64 v[44:45], 0
v_mov_b64 v[46:47], 0
v_mov_b64 v[48:49], 0
v_mov_b64 v[50:51], 0
v_mov_b64 v[52:53], 0
v_mov_b64 v[54:55], 0
v_mov_b64 v[56:57], 0
v_mov_b64 v[58:59], 0
s_waitcnt lgkmcnt(0)
v_pk_add_f32 v[100:101], v[100:101], v[102:103]
v_pk_add_f32 v[104:105], v[104:105], v[106:107]
v_pk_add_f32 v[100:101], v[100:101], v[104:105]
v_cvt_pk_bf16_f32 v214, v100, v101
v_lshlrev_b32 v158, 16, v214
v_and_b32 v159, 0xffff0000, v214
v_mul_f32 v158, s46, v158
v_mul_f32 v159, s46, v159
s_sleep 2
L_r4_B1:
global_load_dwordx3 v[36:38], v171, s[38:39] sc1
global_load_dwordx4 v[20:23], v170, s[38:39] sc1
global_load_dwordx4 v[24:27], v170, s[38:39] offset:2048 sc1
s_add_u32 s15, s15, 1
s_cmp_lt_u32 s15, 100000
s_cbranch_scc0 L_fail
s_waitcnt vmcnt(2)
v_max_f32_dpp v142, v36, v36 quad_perm:[1,0,3,2] row_mask:0xf bank_mask:0xf
v_max_u32 v218, v36, v38
s_nop 0
v_max_f32_dpp v142, v142, v142 quad_perm:[2,3,0,1] row_mask:0xf bank_mask:0xf
s_nop 1
v_max_f32_dpp v142, v142, v142 row_half_mirror row_mask:0xf bank_mask:0xf
s_nop 1
v_subrev_f32_dpp v212, v142, v36 row_newbcast:0 row_mask:0xf bank_mask:0xf
v_exp_f32 v212, v212
s_waitcnt vmcnt(1)
v_max3_u32 v218, v218, v20, v21
v_max3_u32 v218, v218, v22, v23
v_perm_b32 v213, v212, v212, s56
v_mul_f32 v143, v212, v38
s_nop 0
v_and_b32_dpp v84, v213, v16 row_newbcast:8 row_mask:0xf bank_mask:0xf
v_and_b32_dpp v85, v213, v17 row_newbcast:8 row_mask:0xf bank_mask:0xf
v_and_b32_dpp v86, v213, v18 row_newbcast:8 row_mask:0xf bank_mask:0xf
v_and_b32_dpp v87, v213, v19 row_newbcast:8 row_mask:0xf bank_mask:0xf
v_and_b32_dpp v88, v213, v16 row_newbcast:9 row_mask:0xf bank_mask:0xf
v_and_b32_dpp v89, v213, v17 row_newbcast:9 row_mask:0xf bank_mask:0xf
v_mfma_f32_16x16x32_bf16 v[40:43], v[84:87], v[20:23], 0
v_and_b32_dpp v90, v213, v18 row_newbcast:9 row_mask:0xf bank_mask:0xf
v_and_b32_dpp v91, v213, v19 row_newbcast:9 row_mask:0xf bank_mask:0xf
v_add_f32_dpp v143, v143, v143 quad_perm:[1,0,3,2] row_mask:0xf bank_mask:0xf
s_waitcnt vmcnt(0)
v_mfma_f32_16x16x32_bf16 v[40:43], v[88:91], v[24:27], v[40:43]
v_max3_u32 v218, v218, v24, v25
v_max3_u32 v218, v218, v26, v27
v_add_f32_dpp v143, v143, v143 quad_perm:[2,3,0,1] row_mask:0xf bank_mask:0xf
v_cmp_eq_u32 vcc, -1, v218
s_nop 0
v_add_f32_dpp v143, v143, v143 row_half_mirror row_mask:0xf bank_mask:0xf
s_cbranch_vccnz L_r4_B1
s_mov_b64 exec, 1
ds_write_b64 v200, v[142:143]
s_mov_b64 exec, -1
v_cvt_pk_bf16_f32 v140, v40, v41
v_cvt_pk_bf16_f32 v141, v42, v43
ds_write2_b32 v191, v140, v141 offset0:0 offset1:8
s_waitcnt lgkmcnt(0)
s_barrier
ds_read_b128 v[84:87], v194 offset:4224
ds_read_b128 v[100:103], v201
ds_read_b128 v[104:107], v202
ds_read_b128 v[88:91], v194 offset:5280
s_mov_b64 exec, s[70:71]
global_store_dword v181, v223, s[28:29] sc1
s_mov_b64 exec, -1
s_waitcnt lgkmcnt(3)
v_smfmac_f32_16x16x64_bf16 v[44:47], v[84:87], a[128:135], v208
s_waitcnt lgkmcnt(1)
v_max3_f32 v212, v100, v102, v104
v_smfmac_f32_16x16x64_bf16 v[48:51], v[84:87], a[144:151], v208
v_max_f32 v212, v212, v106
v_sub_f32 v92, v100, v212
s_waitcnt lgkmcnt(0)
v_smfmac_f32_16x16x64_bf16 v[44:47], v[88:91], a[136:143], v208
v_sub_f32 v93, v102, v212
v_exp_f32 v92, v92
v_smfmac_f32_16x16x64_bf16 v[48:51], v[88:91], a[152:159], v208
v_sub_f32 v94, v104, v212
v_exp_f32 v93, v93
v_smfmac_f32_16x16x64_bf16 v[52:55], v[84:87], a[160:167], v208
v_sub_f32 v95, v106, v212
v_exp_f32 v94, v94
v_smfmac_f32_16x16x64_bf16 v[56:59], v[84:87], a[176:183], v208
v_mul_f32 v213, v92, v101
v_exp_f32 v95, v95
v_smfmac_f32_16x16x64_bf16 v[52:55], v[88:91], a[168:175], v208
v_fma_f32 v213, v93, v103, v213
v_fma_f32 v213, v94, v105, v213
v_smfmac_f32_16x16x64_bf16 v[56:59], v[88:91], a[184:191], v208
v_fma_f32 v213, v95, v107, v213
v_rcp_f32 v213, v213
v_pk_add_f32 v[146:147], v[44:45], v[46:47]
v_pk_add_f32 v[148:149], v[48:49], v[50:51]
v_mul_f32 v146, v146, v92
v_mul_f32 v148, v148, v92
v_fma_f32 v146, v147, v93, v146
v_fma_f32 v148, v149, v93, v148
v_pk_add_f32 v[150:151], v[52:53], v[54:55]
v_pk_add_f32 v[152:153], v[56:57], v[58:59]
v_permlane16_swap_b32 v146, v148
v_mul_f32 v150, v150, v92
v_mul_f32 v152, v152, v92
v_fma_f32 v150, v151, v93, v150
v_fma_f32 v152, v153, v93, v152
v_add_f32 v146, v146, v148
v_fma_f32 v146, v146, v213, v158
v_permlane16_swap_b32 v150, v152
v_add_f32 v150, v150, v152
v_fma_f32 v150, v150, v213, v159
v_cvt_pk_bf16_f32 v212, v146, v150
global_store_dword v176, v212, s[38:39] sc1
s_cmp_eq_u32 s70, 0
s_cbranch_scc1 L_lx_B1
s_lshl_b32 s72, s35, 2
s_lshl_b32 s72, 15, s72
v_add_u32 v166, 262144, v166
s_mov_b32 s70, 0
s_add_u32 s26, s26, 2
s_mov_b64 s[38:39], s[40:41]
s_branch L_lp_B1
L_lx_B1:
s_sub_u32 s26, s26, 2
s_and_b32 s57, s33, 3
s_xor_b32 s57, s57, s31
s_or_b32 s57, s57, s34
s_cmp_eq_u32 s57, 0
s_cbranch_scc0 L_fail
v_add_u32 v166, 131072, v166
s_lshl_b32 s57, s33, 8
s_sub_u32 s57, s57, 4320
v_lshrrev_b32 v215, 1, v192
v_add_u32 v215, s57, v215
v_mov_b32 v216, 1736704
v_mov_b32 v162, s26
v_lshrrev_b32 v212, 2, v210
v_and_b32 v213, 3, v210
v_lshlrev_b32 v214, 4, v210
v_sub_u32 v166, v166, v214
v_lshl_add_u32 v166, v212, 11, v166
v_lshlrev_b32 v213, 4, v213
v_add_u32 v166, v166, v213
s_mul_i32 s57, s30, 1984
v_mov_b32 v214, s57
v_sub_u32 v166, v166, v214
s_lshl_b32 s57, s33, 8
s_lshl_b32 s58, s30, 6
s_add_u32 s57, s57, s58
v_and_b32 v215, 1, v211
v_lshl_add_u32 v215, v215, 3, v213
v_add_u32 v215, s57, v215
s_waitcnt vmcnt(0)
L_r11_B1:
global_load_dwordx4 v[20:23], v166, s[42:43] sc1
global_load_dwordx4 v[24:27], v166, s[42:43] offset:1024 sc1
s_add_u32 s15, s15, 1
s_cmp_lt_u32 s15, 100000
s_cbranch_scc0 L_fail
s_waitcnt vmcnt(1)
v_mfma_f32_16x16x32_bf16 v[40:43], v[4:7], v[20:23], 0
v_max3_u32 v218, v20, v21, v22
v_max_u32 v218, v218, v23
s_waitcnt vmcnt(0)
v_mfma_f32_16x16x32_bf16 v[40:43], v[4:7], v[24:27], v[40:43]
v_max3_u32 v218, v218, v24, v25
v_max3_u32 v218, v218, v26, v27
v_cmp_eq_u32 vcc, -1, v218
s_cbranch_vccnz L_r11_B1
s_nop 3
v_add_f32_dpp v40, v40, v40 row_ror:4 row_mask:0xf bank_mask:0xf
v_add_f32_dpp v41, v41, v41 row_ror:4 row_mask:0xf bank_mask:0xf
v_add_f32_dpp v42, v42, v42 row_ror:4 row_mask:0xf bank_mask:0xf
v_add_f32_dpp v43, v43, v43 row_ror:4 row_mask:0xf bank_mask:0xf
v_add_f32_dpp v40, v40, v40 row_ror:8 row_mask:0xf bank_mask:0xf
v_add_f32_dpp v41, v41, v41 row_ror:8 row_mask:0xf bank_mask:0xf
v_add_f32_dpp v42, v42, v42 row_ror:8 row_mask:0xf bank_mask:0xf
v_add_f32_dpp v43, v43, v43 row_ror:8 row_mask:0xf bank_mask:0xf
v_cvt_pk_bf16_f32 v140, v40, v41
v_cvt_pk_bf16_f32 v141, v42, v43
s_mov_b64 exec, 0xf000f
global_store_dwordx2 v215, v[140:141], s[24:25]
s_or_b32 s57, s33, s30
s_cmp_eq_u32 s57, 0
s_cbranch_scc0 L_fail
s_mov_b64 exec, 1
global_store_dword v216, v162, s[28:29] sc1
s_endpgm
L_cr_B1:
s_sleep 1
s_add_u32 s15, s15, 1
s_cmp_lt_u32 s15, 100000
s_cbranch_scc0 L_fail
global_load_dwordx4 v[20:23], v168, s[38:39] sc1
global_load_dwordx4 v[24:27], v168, s[38:39] offset:1024 sc1
global_load_dwordx4 v[28:31], v168, s[40:41] sc1
global_load_dwordx4 v[32:35], v168, s[40:41] offset:1024 sc1
s_waitcnt vmcnt(0)
s_branch L_cc_B1
L_fail:
L_end:
s_endpgm
.section .rodata,"a"
.p2align 6
.amdhsa_kernel interleave_layers__sliding_block_cached__sliding_block_cached__decode_kernel
  .amdhsa_next_free_vgpr 512
  .amdhsa_next_free_sgpr 102
  .amdhsa_accum_offset 256
  .amdhsa_group_segment_fixed_size 0
  .amdhsa_kernarg_size 104
  .amdhsa_user_sgpr_count 2
  .amdhsa_user_sgpr_kernarg_segment_ptr 1
  .amdhsa_system_sgpr_workgroup_id_x 1
.end_amdhsa_kernel
```
